```python
import torch

def _softmax(x, axis=-1):
    return torch.softmax(x, dim=axis)
def _gelu(x):
    return torch.nn.functional.gelu(x, approximate="tanh")
def _silu(x):
    return torch.nn.functional.silu(x)
def _sigmoid(x):
    return torch.sigmoid(x)
def _layernorm(x, axis=-1, eps=1e-5):
    m = x.mean(dim=axis, keepdim=True)
    v = x.var(dim=axis, keepdim=True, unbiased=False)
    return (x - m) / torch.sqrt(v + eps)
def _scatter_add(tgt, idx, src, axis=0):
    return tgt.clone().index_add_(axis, idx, src)
def _segment_sum(src, seg, n):
    out = torch.zeros((n,) + src.shape[1:], dtype=src.dtype)
    return out.index_add_(0, seg, src)
def _pad(x, pw):
    flat = tuple(v for pair in reversed(pw) for v in pair)
    return torch.nn.functional.pad(x, flat)

kernel_name = 'gated_mix__mha_block_cached__compressed_kv_cla__decode'

def setup_inputs():

    _w = (lambda a: (lambda t: t.to(torch.bfloat16) if t.is_floating_point() else t)(torch.as_tensor(a)))
    def _A_setup():
        B, Sq, D = 2, 1, 512
        H, Sk, Dh = 32, 8192, 128
        return {
            "x": _w((lambda *s: torch.randn(*s, dtype=torch.bfloat16) * 0.05)(B, Sq, D)),
            "k_cache": _w((lambda *s: torch.randn(*s, dtype=torch.bfloat16) * 6.4)(B, H, Sk, Dh)),
            "v_cache": _w((lambda *s: torch.randn(*s, dtype=torch.bfloat16) * 3.2)(B, H, Sk, Dh)),
            "wq": _w((lambda *s: torch.randn(*s, dtype=torch.bfloat16) * 6.4)(D, H * Dh) * (D ** -0.5)),
            "wo": _w((lambda *s: torch.randn(*s, dtype=torch.bfloat16) * 3.2)(H * Dh, D) * ((H * Dh) ** -0.5)),
        }
    _A_in = _A_setup()

    def _B_setup():
        B, H, Sq, Sk, D, M = 2, 32, 1, 8192, 128, 512
        Dc = 4 * D
        return {
            "x": _w((lambda *s: torch.randn(*s, dtype=torch.bfloat16) * 0.05)(B, Sq, M)),
            "c_kv": _w((lambda *s: torch.randn(*s, dtype=torch.bfloat16) * 1.6)(B, Sk, Dc)),
            "w_q": _w((lambda *s: torch.randn(*s, dtype=torch.bfloat16) * 6.4)(M, H, D) * (M ** -0.5)),
            "w_uk": _w((lambda *s: torch.randn(*s, dtype=torch.bfloat16) * 6.4)(Dc, H, D) * (Dc ** -0.5)),
            "w_uv": _w((lambda *s: torch.randn(*s, dtype=torch.bfloat16) * 1.6)(Dc, H, D) * (Dc ** -0.5)),
            "w_o": _w((lambda *s: torch.randn(*s, dtype=torch.bfloat16) * 1.6)(H, D, M) * ((H * D) ** -0.5)),
        }
    _B_in = _B_setup()

    return {
        "A_x": _A_in["x"],
        "A_k_cache": _A_in["k_cache"],
        "A_v_cache": _A_in["v_cache"],
        "A_wq": _A_in["wq"],
        "A_wo": _A_in["wo"],
        "B_x": _B_in["x"],
        "B_c_kv": _B_in["c_kv"],
        "B_w_q": _B_in["w_q"],
        "B_w_uk": _B_in["w_uk"],
        "B_w_uv": _B_in["w_uv"],
        "B_w_o": _B_in["w_o"],
        "gate_w": _w((lambda *s: torch.randn(*s, dtype=torch.bfloat16) * 0.1)(512) * 16.0),
    }

def reference(A_x, A_k_cache, A_v_cache, A_wq, A_wo, B_x, B_c_kv, B_w_q, B_w_uk, B_w_uv, B_w_o, gate_w):
    def _A_ref(x, k_cache, v_cache, wq, wo):
        B, Sq, D = x.shape
        H, Dh = 32, 128
        q = (lambda x, *d: x.permute(*d))((x @ wq).reshape(B, Sq, H, Dh), 0, 2, 1, 3)
        scores = torch.einsum("bhqd,bhkd->bhqk", q, k_cache) * (Dh ** -0.5)
        p = _softmax(scores, axis=-1)
        o = torch.einsum("bhqk,bhkd->bhqd", p, v_cache)
        return (lambda x, *d: x.permute(*d))(o, 0, 2, 1, 3).reshape(B, Sq, H * Dh) @ wo

    def _B_ref(x, c_kv, w_q, w_uk, w_uv, w_o):
        B, Sq, M = x.shape[0], x.shape[1], x.shape[2]
        Sk = c_kv.shape[1]
        H, D = w_q.shape[1], w_q.shape[2]
        q = torch.einsum("bqm,mhd->bhqd", x, w_q)
        k = torch.einsum("bkc,chd->bhkd", c_kv, w_uk)
        v = torch.einsum("bkc,chd->bhkd", c_kv, w_uv)
        scores = torch.einsum("bhqd,bhkd->bhqk", q, k) * (D ** -0.5)
        off = Sk - Sq
        qi = torch.arange(Sq)[:, None]
        kj = torch.arange(Sk)[None, :]
        cmask = kj <= (qi + off)
        scores = torch.where(cmask[None, None], scores, -1e9)
        p = _softmax(scores, axis=-1)
        ctx = torch.einsum("bhqk,bhkd->bhqd", p, v)
        return torch.einsum("bhqd,hdm->bqm", ctx, w_o)

    x = A_x
    g = _sigmoid((x * gate_w).sum(-1, keepdims=True))
    a = _A_ref(x, A_k_cache, A_v_cache, A_wq, A_wo)
    b = _B_ref(x, B_c_kv, B_w_q, B_w_uk, B_w_uv, B_w_o)
    return g * a + (1 - g) * b
```

```asm
; @launch grid=(256,1,1) block=(512,1,1) lds=135168
.amdgcn_target "amdgcn-amd-amdhsa--gfx950"
.text
.globl gated_mix__mha_block_cached__compressed_kv_cla__decode_kernel
.p2align 8
.type gated_mix__mha_block_cached__compressed_kv_cla__decode_kernel,@function
gated_mix__mha_block_cached__compressed_kv_cla__decode_kernel:
  s_cmp_lt_u32 s2, 32
  s_cbranch_scc1 L_B_entry
  s_cmp_lt_u32 s2, 256
  s_cbranch_scc1 L_A_entry
  s_endpgm
L_A_entry:
  s_load_dwordx8 s[4:11], s[0:1], 0
  s_load_dwordx2 s[12:13], s[0:1], 32
  s_load_dwordx4 s[48:51], s[0:1], 104
  v_lshrrev_b32 v1, 6, v0
  s_nop 0
  v_readfirstlane_b32 s32, v1
  s_sub_u32 s3, s2, 32
  s_and_b32 s33, s3, 7
  s_lshl_b32 s33, s33, 2
  s_lshr_b32 s3, s3, 3
  s_mul_i32 s39, s3, 37
  s_lshr_b32 s39, s39, 8
  s_add_u32 s33, s33, s39
  s_mul_i32 s39, s39, 7
  s_sub_u32 s35, s3, s39
  s_lshl_b32 s3, s35, 3
  s_add_u32 s3, s3, s32
  s_cmp_ge_u32 s3, 28
  s_cselect_b32 s34, 1, 0
  s_cselect_b32 s61, 2, 0
  s_cselect_b32 s39, 586, 0
  s_cselect_b32 s40, 2054, 0
  s_max_u32 s39, s39, 584
  s_mul_i32 s39, s39, s35
  s_sub_u32 s39, s39, s40
  s_and_b32 s60, s32, 3
  s_cmp_lt_u32 s60, s61
  s_cselect_b32 s36, 9, 8
  s_min_u32 s61, s61, s60
  s_add_u32 s61, s61, 296
  s_cmp_lt_u32 s32, 4
  s_cselect_b32 s36, 10, s36
  s_cselect_b32 s61, 0, s61
  s_cselect_b32 s3, 10, 8
  s_add_u32 s3, s3, 64
  s_add_u32 s36, s36, 64
  s_mul_i32 s3, s3, s60
  s_add_u32 s3, s3, s61
  s_add_u32 s3, s3, s39
  s_mov_b32 s54, 0x4000
  s_cmp_ge_u32 s36, 74
  s_cselect_b32 s55, s54, 0x7f000000
  s_cmp_ge_u32 s36, 73
  s_cselect_b32 s59, s54, 0x7f000000
  s_lshl_b32 s39, s34, 5
  s_add_u32 s39, s39, s33
  s_lshl_b32 s39, s39, 11
  s_add_u32 s39, s39, s3
  s_lshl_b32 s39, s39, 10
  s_lshl_b32 s40, s36, 10
  s_sub_u32 s56, s40, 0xc000
  s_sub_u32 s57, s40, 0x8000
  s_and_b32 s37, s32, 3
  s_lshr_b32 s38, s32, 2
  v_and_b32 v1, 63, v0
  v_and_b32 v2, 15, v0
  v_bfe_u32 v3, v0, 4, 2
  v_lshlrev_b32 v4, 4, v1
  v_add_u32 v5, 4096, v4
  v_add_u32 v6, 8192, v4
  v_add_u32 v7, 12288, v4
  v_and_b32 v60, 1, v3
  v_lshlrev_b32 v60, 4, v60
  v_lshl_add_u32 v1, v2, 5, v60
  s_cmp_eq_u32 s35, 3
  s_cselect_b32 s52, -1, 0
  s_cselect_b32 s53, -1, 0
  s_cselect_b32 s58, 0, 1.0
  s_lshl_b32 s41, s33, 2
  s_add_u32 s43, s41, 128
  s_add_u32 s41, s41, s35
  s_cmp_gt_u32 s35, 3
  s_cselect_b32 s3, 125, 0
  s_add_u32 s41, s41, s3
  v_mov_b32 v60, s41
  v_mov_b32 v59, s43
  v_cmp_lt_u32 vcc, 1, v3
  s_nop 1
  v_cndmask_b32 v60, v60, v59, vcc
  s_lshl_b32 s3, s32, 9
  s_add_u32 s3, s3, 4194304
  v_add_u32 v50, s3, v1
  v_lshl_add_u32 v50, v60, 12, v50
  v_lshlrev_b32 v60, 3, v60
  v_add_u32 v51, 131072, v60
  v_mov_b32 v32, -1
  v_mov_b32 v33, -1
  v_mov_b32 v34, -1
  v_mov_b32 v35, -1
  v_lshlrev_b32 v58, 1, v0
  v_sub_u32 v31, v0, v2
  v_lshlrev_b32 v31, 13, v31
  v_lshl_add_u32 v56, v2, 4, v31
  s_mov_b32 s42, 0
  s_lshl_b32 s3, s33, 8
  s_waitcnt lgkmcnt(0)
  s_mov_b32 exec_hi, s52
  global_store_dwordx4 v50, v[32:35], s[50:51] sc1
  s_cmp_lg_u32 s32, 0
  s_nop 0
  s_cbranch_scc1 L_A_mk
  s_and_b32 exec_hi, s52, 1
  s_mov_b32 exec_lo, 1
  global_store_dwordx2 v51, v[32:33], s[50:51] sc1
L_A_mk:
  s_mov_b64 exec, -1
  global_load_ushort v48, v58, s[4:5]
  global_load_ushort v49, v58, s[4:5] offset:1024
  s_add_u32 s16, s6, s39
  s_addc_u32 s17, s7, 0
  s_mov_b32 s18, s40
  s_mov_b32 s19, 0x00020000
  s_add_u32 s24, s10, s3
  s_addc_u32 s25, s11, 0
  s_mov_b32 s26, 4186368
  s_mov_b32 s27, 0x00020000
  s_add_u32 s20, s8, s39
  s_addc_u32 s21, s9, 0
  s_mov_b32 s22, s40
  s_mov_b32 s23, 0x00020000
  buffer_load_dwordx4 a[64:67], v56, s[24:27], s42 offen nt
  s_add_u32 s42, s42, 0x2000
  buffer_load_dwordx4 a[68:71], v56, s[24:27], s42 offen nt
  s_add_u32 s42, s42, 0x2000
  buffer_load_dwordx4 a[72:75], v56, s[24:27], s42 offen nt
  s_add_u32 s42, s42, 0x2000
  buffer_load_dwordx4 a[76:79], v56, s[24:27], s42 offen nt
  s_add_u32 s42, s42, 0x2000
  buffer_load_dwordx4 a[80:83], v56, s[24:27], s42 offen nt
  s_add_u32 s42, s42, 0x2000
  buffer_load_dwordx4 a[84:87], v56, s[24:27], s42 offen nt
  s_add_u32 s42, s42, 0x2000
  buffer_load_dwordx4 a[88:91], v56, s[24:27], s42 offen nt
  s_add_u32 s42, s42, 0x2000
  buffer_load_dwordx4 a[92:95], v56, s[24:27], s42 offen nt
  s_add_u32 s42, s42, 0x2000
  buffer_load_dwordx4 a[96:99], v56, s[24:27], s42 offen nt
  s_add_u32 s42, s42, 0x2000
  buffer_load_dwordx4 a[100:103], v56, s[24:27], s42 offen nt
  s_add_u32 s42, s42, 0x2000
  buffer_load_dwordx4 a[104:107], v56, s[24:27], s42 offen nt
  s_add_u32 s42, s42, 0x2000
  buffer_load_dwordx4 a[108:111], v56, s[24:27], s42 offen nt
  s_add_u32 s42, s42, 0x2000
  buffer_load_dwordx4 a[112:115], v56, s[24:27], s42 offen nt
  s_add_u32 s42, s42, 0x2000
  buffer_load_dwordx4 a[116:119], v56, s[24:27], s42 offen nt
  s_add_u32 s42, s42, 0x2000
  buffer_load_dwordx4 a[120:123], v56, s[24:27], s42 offen nt
  s_add_u32 s42, s42, 0x2000
  buffer_load_dwordx4 a[124:127], v56, s[24:27], s42 offen nt
  buffer_load_dwordx4 v[64:67], v4, s[16:19], 0 offen offset:0 nt
  buffer_load_dwordx4 v[68:71], v4, s[16:19], 0 offen offset:1024 nt
  buffer_load_dwordx4 v[72:75], v4, s[16:19], 0 offen offset:2048 nt
  buffer_load_dwordx4 v[76:79], v4, s[16:19], 0 offen offset:3072 nt
  buffer_load_dwordx4 v[80:83], v5, s[16:19], 0 offen offset:0 nt
  buffer_load_dwordx4 v[84:87], v5, s[16:19], 0 offen offset:1024 nt
  buffer_load_dwordx4 v[88:91], v5, s[16:19], 0 offen offset:2048 nt
  buffer_load_dwordx4 v[92:95], v5, s[16:19], 0 offen offset:3072 nt
  buffer_load_dwordx4 v[96:99], v6, s[16:19], 0 offen offset:0 nt
  buffer_load_dwordx4 v[100:103], v6, s[16:19], 0 offen offset:1024 nt
  buffer_load_dwordx4 v[104:107], v6, s[16:19], 0 offen offset:2048 nt
  buffer_load_dwordx4 v[108:111], v6, s[16:19], 0 offen offset:3072 nt
  buffer_load_dwordx4 v[112:115], v7, s[16:19], 0 offen offset:0 nt
  buffer_load_dwordx4 v[116:119], v7, s[16:19], 0 offen offset:1024 nt
  buffer_load_dwordx4 v[120:123], v7, s[16:19], 0 offen offset:2048 nt
  buffer_load_dwordx4 v[124:127], v7, s[16:19], 0 offen offset:3072 nt
  v_and_b32 v31, 1, v2
  v_lshlrev_b32 v31, 4, v31
  v_mov_b32 v59, 0xffff
  v_lshlrev_b32 v59, v31, v59
  v_bfe_u32 v31, v2, 1, 2
  v_cmp_eq_u32 vcc, 0, v31
  s_nop 1
  v_cndmask_b32 v8, 0, v59, vcc
  v_cmp_eq_u32 vcc, 1, v31
  s_nop 1
  v_cndmask_b32 v9, 0, v59, vcc
  v_cmp_eq_u32 vcc, 2, v31
  s_nop 1
  v_cndmask_b32 v10, 0, v59, vcc
  v_cmp_eq_u32 vcc, 3, v31
  s_nop 1
  v_cndmask_b32 v11, 0, v59, vcc
  v_mov_b32 v31, 0x0100
  v_mov_b32 v59, 0x0302
  v_cmp_gt_u32 vcc, 8, v2
  s_nop 1
  v_cndmask_b32 v31, v59, v31, vcc
  v_lshlrev_b32 v59, 16, v31
  v_or_b32 v59, 0x0c0c, v59
  v_or_b32 v31, 0x0c0c0000, v31
  v_and_b32 v60, 1, v2
  v_cmp_eq_u32 vcc, 1, v60
  s_nop 1
  v_cndmask_b32 v31, v31, v59, vcc
  v_bfe_u32 v59, v2, 1, 2
  v_mov_b32 v60, 0x0c0c0c0c
  v_cmp_eq_u32 vcc, 0, v59
  s_nop 1
  v_cndmask_b32 v52, v60, v31, vcc
  v_cmp_eq_u32 vcc, 1, v59
  s_nop 1
  v_cndmask_b32 v53, v60, v31, vcc
  v_cmp_eq_u32 vcc, 2, v59
  s_nop 1
  v_cndmask_b32 v54, v60, v31, vcc
  v_cmp_eq_u32 vcc, 3, v59
  s_nop 1
  v_cndmask_b32 v55, v60, v31, vcc
  s_mov_b32 s44, 0xcccccccc
  s_mov_b32 s45, 0xcccccccc
  s_mov_b32 s46, 0xaaaaaaaa
  s_mov_b32 s47, 0xaaaaaaaa
  v_mov_b32 v57, 0xff800000
  s_lshl_b32 s3, s32, 9
  v_add_u32 v63, s3, v1
  v_lshrrev_b32 v31, 1, v3
  v_lshl_add_u32 v31, v31, 9, v63
  v_add_u32 v60, s3, v31
  s_lshl_b32 s3, s34, 9
  v_lshl_add_u32 v31, v3, 11, s3
  v_lshl_add_u32 v62, v2, 5, v31
  s_lshl_b32 s3, s37, 8
  s_lshl_b32 s39, s38, 16
  s_add_u32 s3, s3, s39
  v_lshl_add_u32 v31, v2, 4, s3
  v_lshl_add_u32 v61, v3, 14, v31
  v_mov_b32 v28, 0xff800000
  v_mov_b32 v29, 0
  s_waitcnt vmcnt(32)
  v_lshl_or_b32 v48, v49, 16, v48
  s_waitcnt vmcnt(31)
  s_nop 0
  v_mov_b32_dpp v58, v48 row_newbcast:0 row_mask:0xf bank_mask:0xf
  v_perm_b32 v16, v58, v58, v52
  v_perm_b32 v17, v58, v58, v53
  v_perm_b32 v18, v58, v58, v54
  v_perm_b32 v19, v58, v58, v55
  s_nop 1
  v_mfma_f32_16x16x32_bf16 v[24:27], v[16:19], a[64:67], 0
  s_waitcnt vmcnt(30)
  v_mov_b32_dpp v59, v48 row_newbcast:1 row_mask:0xf bank_mask:0xf
  v_perm_b32 v20, v59, v59, v52
  v_perm_b32 v21, v59, v59, v53
  v_perm_b32 v22, v59, v59, v54
  v_perm_b32 v23, v59, v59, v55
  s_nop 1
  v_mfma_f32_16x16x32_bf16 v[24:27], v[20:23], a[68:71], v[24:27]
  s_waitcnt vmcnt(29)
  v_mov_b32_dpp v58, v48 row_newbcast:2 row_mask:0xf bank_mask:0xf
  v_perm_b32 v16, v58, v58, v52
  v_perm_b32 v17, v58, v58, v53
  v_perm_b32 v18, v58, v58, v54
  v_perm_b32 v19, v58, v58, v55
  s_nop 1
  v_mfma_f32_16x16x32_bf16 v[24:27], v[16:19], a[72:75], v[24:27]
  s_waitcnt vmcnt(28)
  v_mov_b32_dpp v59, v48 row_newbcast:3 row_mask:0xf bank_mask:0xf
  v_perm_b32 v20, v59, v59, v52
  v_perm_b32 v21, v59, v59, v53
  v_perm_b32 v22, v59, v59, v54
  v_perm_b32 v23, v59, v59, v55
  s_nop 1
  v_mfma_f32_16x16x32_bf16 v[24:27], v[20:23], a[76:79], v[24:27]
  s_waitcnt vmcnt(27)
  v_mov_b32_dpp v58, v48 row_newbcast:4 row_mask:0xf bank_mask:0xf
  v_perm_b32 v16, v58, v58, v52
  v_perm_b32 v17, v58, v58, v53
  v_perm_b32 v18, v58, v58, v54
  v_perm_b32 v19, v58, v58, v55
  s_nop 1
  v_mfma_f32_16x16x32_bf16 v[24:27], v[16:19], a[80:83], v[24:27]
  s_waitcnt vmcnt(26)
  v_mov_b32_dpp v59, v48 row_newbcast:5 row_mask:0xf bank_mask:0xf
  v_perm_b32 v20, v59, v59, v52
  v_perm_b32 v21, v59, v59, v53
  v_perm_b32 v22, v59, v59, v54
  v_perm_b32 v23, v59, v59, v55
  s_nop 1
  v_mfma_f32_16x16x32_bf16 v[24:27], v[20:23], a[84:87], v[24:27]
  s_waitcnt vmcnt(25)
  v_mov_b32_dpp v58, v48 row_newbcast:6 row_mask:0xf bank_mask:0xf
  v_perm_b32 v16, v58, v58, v52
  v_perm_b32 v17, v58, v58, v53
  v_perm_b32 v18, v58, v58, v54
  v_perm_b32 v19, v58, v58, v55
  s_nop 1
  v_mfma_f32_16x16x32_bf16 v[24:27], v[16:19], a[88:91], v[24:27]
  s_waitcnt vmcnt(24)
  v_mov_b32_dpp v59, v48 row_newbcast:7 row_mask:0xf bank_mask:0xf
  v_perm_b32 v20, v59, v59, v52
  v_perm_b32 v21, v59, v59, v53
  v_perm_b32 v22, v59, v59, v54
  v_perm_b32 v23, v59, v59, v55
  s_nop 1
  v_mfma_f32_16x16x32_bf16 v[24:27], v[20:23], a[92:95], v[24:27]
  s_waitcnt vmcnt(23)
  v_mov_b32_dpp v58, v48 row_newbcast:8 row_mask:0xf bank_mask:0xf
  v_perm_b32 v16, v58, v58, v52
  v_perm_b32 v17, v58, v58, v53
  v_perm_b32 v18, v58, v58, v54
  v_perm_b32 v19, v58, v58, v55
  s_nop 1
  v_mfma_f32_16x16x32_bf16 v[24:27], v[16:19], a[96:99], v[24:27]
  s_waitcnt vmcnt(22)
  v_mov_b32_dpp v59, v48 row_newbcast:9 row_mask:0xf bank_mask:0xf
  v_perm_b32 v20, v59, v59, v52
  v_perm_b32 v21, v59, v59, v53
  v_perm_b32 v22, v59, v59, v54
  v_perm_b32 v23, v59, v59, v55
  s_nop 1
  v_mfma_f32_16x16x32_bf16 v[24:27], v[20:23], a[100:103], v[24:27]
  s_waitcnt vmcnt(21)
  v_mov_b32_dpp v58, v48 row_newbcast:10 row_mask:0xf bank_mask:0xf
  v_perm_b32 v16, v58, v58, v52
  v_perm_b32 v17, v58, v58, v53
  v_perm_b32 v18, v58, v58, v54
  v_perm_b32 v19, v58, v58, v55
  s_nop 1
  v_mfma_f32_16x16x32_bf16 v[24:27], v[16:19], a[104:107], v[24:27]
  s_waitcnt vmcnt(20)
  v_mov_b32_dpp v59, v48 row_newbcast:11 row_mask:0xf bank_mask:0xf
  v_perm_b32 v20, v59, v59, v52
  v_perm_b32 v21, v59, v59, v53
  v_perm_b32 v22, v59, v59, v54
  v_perm_b32 v23, v59, v59, v55
  s_nop 1
  v_mfma_f32_16x16x32_bf16 v[24:27], v[20:23], a[108:111], v[24:27]
  s_waitcnt vmcnt(19)
  v_mov_b32_dpp v58, v48 row_newbcast:12 row_mask:0xf bank_mask:0xf
  v_perm_b32 v16, v58, v58, v52
  v_perm_b32 v17, v58, v58, v53
  v_perm_b32 v18, v58, v58, v54
  v_perm_b32 v19, v58, v58, v55
  s_nop 1
  v_mfma_f32_16x16x32_bf16 v[24:27], v[16:19], a[112:115], v[24:27]
  s_waitcnt vmcnt(18)
  v_mov_b32_dpp v59, v48 row_newbcast:13 row_mask:0xf bank_mask:0xf
  v_perm_b32 v20, v59, v59, v52
  v_perm_b32 v21, v59, v59, v53
  v_perm_b32 v22, v59, v59, v54
  v_perm_b32 v23, v59, v59, v55
  s_nop 1
  v_mfma_f32_16x16x32_bf16 v[24:27], v[20:23], a[116:119], v[24:27]
  s_waitcnt vmcnt(17)
  v_mov_b32_dpp v58, v48 row_newbcast:14 row_mask:0xf bank_mask:0xf
  v_perm_b32 v16, v58, v58, v52
  v_perm_b32 v17, v58, v58, v53
  v_perm_b32 v18, v58, v58, v54
  v_perm_b32 v19, v58, v58, v55
  s_nop 1
  v_mfma_f32_16x16x32_bf16 v[24:27], v[16:19], a[120:123], v[24:27]
  s_waitcnt vmcnt(16)
  v_mov_b32_dpp v59, v48 row_newbcast:15 row_mask:0xf bank_mask:0xf
  v_perm_b32 v20, v59, v59, v52
  v_perm_b32 v21, v59, v59, v53
  v_perm_b32 v22, v59, v59, v54
  v_perm_b32 v23, v59, v59, v55
  s_nop 1
  v_mfma_f32_16x16x32_bf16 v[24:27], v[20:23], a[124:127], v[24:27]
  s_lshl_b32 s3, s33, 17
  s_add_u32 s24, s12, s3
  s_addc_u32 s25, s13, 0
  s_mov_b32 s26, 131072
  s_mov_b32 s27, 0x00020000
  v_mov_b32 v56, v61
  s_mov_b32 s42, 0
  s_nop 0
  ds_write_b128 v60, v[24:27]
  s_waitcnt lgkmcnt(0)
  s_barrier
  s_cmp_lg_u32 s32, 0
  s_cbranch_scc1 L_A_c4
  s_mov_b64 exec, 1
  v_mov_b32 v58, 0
  v_mov_b32 v59, 1
  global_atomic_add v58, v59, s[48:49] offset:68 sc1
  s_mov_b64 exec, -1
L_A_c4:
  ds_read_b128 v[32:35], v62 offset:0
  ds_read_b128 v[36:39], v62 offset:16
  ds_read_b128 v[40:43], v62 offset:1024
  ds_read_b128 v[44:47], v62 offset:1040
  v_mov_b32 v24, 0
  v_mov_b32 v25, 0
  v_mov_b32 v26, 0
  v_mov_b32 v27, 0
  s_waitcnt lgkmcnt(0)
  v_pk_add_f32 v[32:33], v[32:33], v[40:41]
  v_pk_add_f32 v[34:35], v[34:35], v[42:43]
  v_pk_add_f32 v[36:37], v[36:37], v[44:45]
  v_pk_add_f32 v[38:39], v[38:39], v[46:47]
  s_nop 0
  v_permlane32_swap_b32 v32, v36
  v_permlane32_swap_b32 v33, v37
  v_permlane32_swap_b32 v34, v38
  v_permlane32_swap_b32 v35, v39
  v_pk_add_f32 v[32:33], v[32:33], v[36:37]
  v_pk_add_f32 v[34:35], v[34:35], v[38:39]
  s_nop 1
  v_permlane16_swap_b32 v32, v34
  v_permlane16_swap_b32 v33, v35
  v_pk_add_f32 v[32:33], v[32:33], v[34:35]
  v_cvt_pk_bf16_f32 v12, v32, v33
  v_mov_b32 v13, v12
  s_nop 1
  v_permlane16_swap_b32 v12, v13
  v_mov_b32 v14, v12
  v_mov_b32 v15, v13
  s_nop 0
  v_permlane32_swap_b32 v12, v14
  v_permlane32_swap_b32 v13, v15
  s_waitcnt vmcnt(15)
  v_dot2_f32_bf16 v32, v64, v12, 0
  v_dot2_f32_bf16 v32, v65, v13, v32
  v_dot2_f32_bf16 v32, v66, v14, v32
  v_dot2_f32_bf16 v32, v67, v15, v32
  s_waitcnt vmcnt(14)
  v_dot2_f32_bf16 v33, v68, v12, 0
  v_dot2_f32_bf16 v33, v69, v13, v33
  v_dot2_f32_bf16 v33, v70, v14, v33
  v_dot2_f32_bf16 v33, v71, v15, v33
  s_waitcnt vmcnt(13)
  v_dot2_f32_bf16 v34, v72, v12, 0
  v_dot2_f32_bf16 v34, v73, v13, v34
  v_dot2_f32_bf16 v34, v74, v14, v34
  v_dot2_f32_bf16 v34, v75, v15, v34
  s_waitcnt vmcnt(12)
  v_dot2_f32_bf16 v35, v76, v12, 0
  v_dot2_f32_bf16 v35, v77, v13, v35
  v_dot2_f32_bf16 v35, v78, v14, v35
  v_dot2_f32_bf16 v35, v79, v15, v35
  s_waitcnt vmcnt(11)
  v_dot2_f32_bf16 v36, v80, v12, 0
  v_dot2_f32_bf16 v36, v81, v13, v36
  v_dot2_f32_bf16 v36, v82, v14, v36
  v_dot2_f32_bf16 v36, v83, v15, v36
  buffer_load_dwordx4 a[64:67], v56, s[24:27], s42 offen offset:0 nt
  s_waitcnt vmcnt(11)
  v_dot2_f32_bf16 v37, v84, v12, 0
  v_dot2_f32_bf16 v37, v85, v13, v37
  v_dot2_f32_bf16 v37, v86, v14, v37
  v_dot2_f32_bf16 v37, v87, v15, v37
  s_waitcnt vmcnt(10)
  v_dot2_f32_bf16 v38, v88, v12, 0
  v_dot2_f32_bf16 v38, v89, v13, v38
  v_dot2_f32_bf16 v38, v90, v14, v38
  v_dot2_f32_bf16 v38, v91, v15, v38
  buffer_load_dwordx4 a[68:71], v56, s[24:27], s42 offen offset:1024 nt
  s_waitcnt vmcnt(10)
  v_dot2_f32_bf16 v39, v92, v12, 0
  v_dot2_f32_bf16 v39, v93, v13, v39
  v_dot2_f32_bf16 v39, v94, v14, v39
  v_dot2_f32_bf16 v39, v95, v15, v39
  s_waitcnt vmcnt(9)
  v_dot2_f32_bf16 v40, v96, v12, 0
  v_dot2_f32_bf16 v40, v97, v13, v40
  v_dot2_f32_bf16 v40, v98, v14, v40
  v_dot2_f32_bf16 v40, v99, v15, v40
  buffer_load_dwordx4 a[72:75], v56, s[24:27], s42 offen offset:2048 nt
  s_waitcnt vmcnt(9)
  v_dot2_f32_bf16 v41, v100, v12, 0
  v_dot2_f32_bf16 v41, v101, v13, v41
  v_dot2_f32_bf16 v41, v102, v14, v41
  v_dot2_f32_bf16 v41, v103, v15, v41
  v_add_f32_dpp v32, v32, v32 row_ror:8 row_mask:0xf bank_mask:0x3
  s_nop 1
  v_add_f32_dpp v32, v40, v40 row_ror:8 row_mask:0xf bank_mask:0xc
  s_waitcnt vmcnt(8)
  v_dot2_f32_bf16 v42, v104, v12, 0
  v_dot2_f32_bf16 v42, v105, v13, v42
  v_dot2_f32_bf16 v42, v106, v14, v42
  v_dot2_f32_bf16 v42, v107, v15, v42
  buffer_load_dwordx4 a[76:79], v56, s[24:27], s42 offen offset:3072 nt
  s_add_u32 s42, s42, 0x1000
  v_add_f32_dpp v33, v33, v33 row_ror:8 row_mask:0xf bank_mask:0x3
  s_nop 1
  v_add_f32_dpp v33, v41, v41 row_ror:8 row_mask:0xf bank_mask:0xc
  s_waitcnt vmcnt(8)
  v_dot2_f32_bf16 v43, v108, v12, 0
  v_dot2_f32_bf16 v43, v109, v13, v43
  v_dot2_f32_bf16 v43, v110, v14, v43
  v_dot2_f32_bf16 v43, v111, v15, v43
  v_add_f32_dpp v34, v34, v34 row_ror:8 row_mask:0xf bank_mask:0x3
  s_nop 1
  v_add_f32_dpp v34, v42, v42 row_ror:8 row_mask:0xf bank_mask:0xc
  s_waitcnt vmcnt(7)
  buffer_load_dwordx4 a[0:3], v4, s[20:23], 0 offen offset:0 nt
  v_dot2_f32_bf16 v44, v112, v12, 0
  v_dot2_f32_bf16 v44, v113, v13, v44
  v_dot2_f32_bf16 v44, v114, v14, v44
  v_dot2_f32_bf16 v44, v115, v15, v44
  buffer_load_dwordx4 a[80:83], v56, s[24:27], s42 offen offset:0 nt
  v_add_f32_dpp v35, v35, v35 row_ror:8 row_mask:0xf bank_mask:0x3
  s_nop 1
  v_add_f32_dpp v35, v43, v43 row_ror:8 row_mask:0xf bank_mask:0xc
  s_waitcnt vmcnt(8)
  buffer_load_dwordx4 a[4:7], v4, s[20:23], 0 offen offset:1024 nt
  v_dot2_f32_bf16 v45, v116, v12, 0
  v_dot2_f32_bf16 v45, v117, v13, v45
  v_dot2_f32_bf16 v45, v118, v14, v45
  v_dot2_f32_bf16 v45, v119, v15, v45
  v_add_f32_dpp v36, v36, v36 row_ror:8 row_mask:0xf bank_mask:0x3
  s_nop 1
  v_add_f32_dpp v36, v44, v44 row_ror:8 row_mask:0xf bank_mask:0xc
  s_waitcnt vmcnt(8)
  buffer_load_dwordx4 a[8:11], v4, s[20:23], 0 offen offset:2048 nt
  v_dot2_f32_bf16 v46, v120, v12, 0
  v_dot2_f32_bf16 v46, v121, v13, v46
  v_dot2_f32_bf16 v46, v122, v14, v46
  v_dot2_f32_bf16 v46, v123, v15, v46
  buffer_load_dwordx4 a[84:87], v56, s[24:27], s42 offen offset:1024 nt
  v_add_f32_dpp v37, v37, v37 row_ror:8 row_mask:0xf bank_mask:0x3
  s_nop 1
  v_add_f32_dpp v37, v45, v45 row_ror:8 row_mask:0xf bank_mask:0xc
  s_waitcnt vmcnt(9)
  buffer_load_dwordx4 a[12:15], v4, s[20:23], 0 offen offset:3072 nt
  v_dot2_f32_bf16 v47, v124, v12, 0
  v_dot2_f32_bf16 v47, v125, v13, v47
  v_dot2_f32_bf16 v47, v126, v14, v47
  v_dot2_f32_bf16 v47, v127, v15, v47
  v_add_f32_dpp v38, v38, v38 row_ror:8 row_mask:0xf bank_mask:0x3
  s_nop 1
  v_add_f32_dpp v38, v46, v46 row_ror:8 row_mask:0xf bank_mask:0xc
  v_add_f32_dpp v39, v39, v39 row_ror:8 row_mask:0xf bank_mask:0x3
  s_nop 1
  v_add_f32_dpp v39, v47, v47 row_ror:8 row_mask:0xf bank_mask:0xc
  v_add_f32_dpp v32, v32, v32 row_half_mirror row_mask:0xf bank_mask:0x5
  s_nop 1
  v_add_f32_dpp v32, v36, v36 row_half_mirror row_mask:0xf bank_mask:0xa
  v_add_f32_dpp v33, v33, v33 row_half_mirror row_mask:0xf bank_mask:0x5
  s_nop 1
  v_add_f32_dpp v33, v37, v37 row_half_mirror row_mask:0xf bank_mask:0xa
  v_add_f32_dpp v34, v34, v34 row_half_mirror row_mask:0xf bank_mask:0x5
  s_nop 1
  v_add_f32_dpp v34, v38, v38 row_half_mirror row_mask:0xf bank_mask:0xa
  v_add_f32_dpp v35, v35, v35 row_half_mirror row_mask:0xf bank_mask:0x5
  s_nop 1
  v_add_f32_dpp v35, v39, v39 row_half_mirror row_mask:0xf bank_mask:0xa
  v_add_f32_dpp v32, v32, v32 quad_perm:[2,3,0,1] row_mask:0xf bank_mask:0xf
  v_add_f32_dpp v33, v33, v33 quad_perm:[2,3,0,1] row_mask:0xf bank_mask:0xf
  v_add_f32_dpp v34, v34, v34 quad_perm:[2,3,0,1] row_mask:0xf bank_mask:0xf
  v_add_f32_dpp v35, v35, v35 quad_perm:[2,3,0,1] row_mask:0xf bank_mask:0xf
  v_cndmask_b32 v32, v32, v34, s[44:45]
  v_cndmask_b32 v33, v33, v35, s[44:45]
  s_nop 0
  v_add_f32_dpp v32, v32, v32 quad_perm:[1,0,3,2] row_mask:0xf bank_mask:0xf
  v_add_f32_dpp v33, v33, v33 quad_perm:[1,0,3,2] row_mask:0xf bank_mask:0xf
  v_cndmask_b32 v32, v32, v33, s[46:47]
  v_cvt_pk_bf16_f32 v32, v32, v32
  v_lshlrev_b32 v32, 16, v32
  v_mul_f32 v32, 0x3db504f3, v32
  v_cvt_pk_bf16_f32 v32, v32, v32
  v_lshlrev_b32 v32, 16, v32
  v_mul_f32 v32, 0x3fb8aa3b, v32
  v_max_f32 v58, v32, v28
  s_nop 1
  v_max_f32_dpp v58, v58, v58 row_ror:8 row_mask:0xf bank_mask:0xf
  s_nop 1
  v_max_f32_dpp v58, v58, v58 row_ror:4 row_mask:0xf bank_mask:0xf
  s_nop 1
  v_max_f32_dpp v58, v58, v58 row_ror:2 row_mask:0xf bank_mask:0xf
  s_nop 1
  v_max_f32_dpp v58, v58, v58 row_ror:1 row_mask:0xf bank_mask:0xf
  v_mov_b32 v59, v58
  s_nop 1
  v_permlane16_swap_b32 v58, v59
  v_max_f32 v58, v58, v59
  v_mov_b32 v59, v58
  s_nop 1
  v_permlane32_swap_b32 v58, v59
  v_max_f32 v58, v58, v59
  v_sub_f32 v59, v28, v58
  v_sub_f32 v60, v32, v58
  v_exp_f32 v59, v59
  v_exp_f32 v60, v60
  v_mov_b32 v28, v58
  v_cvt_pk_bf16_f32 v30, v60, v60
  v_fma_f32 v29, v29, v59, v60
  v_mul_f32 v24, v24, v59
  v_mul_f32 v25, v25, v59
  v_mul_f32 v26, v26, v59
  v_mul_f32 v27, v27, v59
  v_and_b32_dpp v16, v30, v8 row_newbcast:0 row_mask:0xf bank_mask:0xf
  v_and_b32_dpp v17, v30, v9 row_newbcast:0 row_mask:0xf bank_mask:0xf
  v_and_b32_dpp v18, v30, v10 row_newbcast:0 row_mask:0xf bank_mask:0xf
  v_and_b32_dpp v19, v30, v11 row_newbcast:0 row_mask:0xf bank_mask:0xf
  s_waitcnt vmcnt(5)
  buffer_load_dwordx4 a[16:19], v5, s[20:23], 0 offen offset:0 nt
  v_mfma_f32_16x16x32_bf16 v[24:27], v[16:19], a[0:3], v[24:27]
  buffer_load_dwordx4 a[88:91], v56, s[24:27], s42 offen offset:2048 nt
  v_and_b32_dpp v20, v30, v8 row_newbcast:1 row_mask:0xf bank_mask:0xf
  v_and_b32_dpp v21, v30, v9 row_newbcast:1 row_mask:0xf bank_mask:0xf
  v_and_b32_dpp v22, v30, v10 row_newbcast:1 row_mask:0xf bank_mask:0xf
  v_and_b32_dpp v23, v30, v11 row_newbcast:1 row_mask:0xf bank_mask:0xf
  s_waitcnt vmcnt(5)
  buffer_load_dwordx4 a[20:23], v5, s[20:23], 0 offen offset:1024 nt
  v_mfma_f32_16x16x32_bf16 v[24:27], v[20:23], a[4:7], v[24:27]
  v_and_b32_dpp v16, v30, v8 row_newbcast:2 row_mask:0xf bank_mask:0xf
  v_and_b32_dpp v17, v30, v9 row_newbcast:2 row_mask:0xf bank_mask:0xf
  v_and_b32_dpp v18, v30, v10 row_newbcast:2 row_mask:0xf bank_mask:0xf
  v_and_b32_dpp v19, v30, v11 row_newbcast:2 row_mask:0xf bank_mask:0xf
  s_waitcnt vmcnt(5)
  buffer_load_dwordx4 a[24:27], v5, s[20:23], 0 offen offset:2048 nt
  v_mfma_f32_16x16x32_bf16 v[24:27], v[16:19], a[8:11], v[24:27]
  buffer_load_dwordx4 a[92:95], v56, s[24:27], s42 offen offset:3072 nt
  s_add_u32 s42, s42, 0x1000
  v_and_b32_dpp v20, v30, v8 row_newbcast:3 row_mask:0xf bank_mask:0xf
  v_and_b32_dpp v21, v30, v9 row_newbcast:3 row_mask:0xf bank_mask:0xf
  v_and_b32_dpp v22, v30, v10 row_newbcast:3 row_mask:0xf bank_mask:0xf
  v_and_b32_dpp v23, v30, v11 row_newbcast:3 row_mask:0xf bank_mask:0xf
  s_waitcnt vmcnt(5)
  buffer_load_dwordx4 a[28:31], v5, s[20:23], 0 offen offset:3072 nt
  v_mfma_f32_16x16x32_bf16 v[24:27], v[20:23], a[12:15], v[24:27]
  v_and_b32_dpp v16, v30, v8 row_newbcast:4 row_mask:0xf bank_mask:0xf
  v_and_b32_dpp v17, v30, v9 row_newbcast:4 row_mask:0xf bank_mask:0xf
  v_and_b32_dpp v18, v30, v10 row_newbcast:4 row_mask:0xf bank_mask:0xf
  v_and_b32_dpp v19, v30, v11 row_newbcast:4 row_mask:0xf bank_mask:0xf
  s_waitcnt vmcnt(5)
  buffer_load_dwordx4 a[32:35], v6, s[20:23], 0 offen offset:0 nt
  v_mfma_f32_16x16x32_bf16 v[24:27], v[16:19], a[16:19], v[24:27]
  buffer_load_dwordx4 a[96:99], v56, s[24:27], s42 offen offset:0 nt
  v_and_b32_dpp v20, v30, v8 row_newbcast:5 row_mask:0xf bank_mask:0xf
  v_and_b32_dpp v21, v30, v9 row_newbcast:5 row_mask:0xf bank_mask:0xf
  v_and_b32_dpp v22, v30, v10 row_newbcast:5 row_mask:0xf bank_mask:0xf
  v_and_b32_dpp v23, v30, v11 row_newbcast:5 row_mask:0xf bank_mask:0xf
  s_waitcnt vmcnt(5)
  buffer_load_dwordx4 a[36:39], v6, s[20:23], 0 offen offset:1024 nt
  v_mfma_f32_16x16x32_bf16 v[24:27], v[20:23], a[20:23], v[24:27]
  v_and_b32_dpp v16, v30, v8 row_newbcast:6 row_mask:0xf bank_mask:0xf
  v_and_b32_dpp v17, v30, v9 row_newbcast:6 row_mask:0xf bank_mask:0xf
  v_and_b32_dpp v18, v30, v10 row_newbcast:6 row_mask:0xf bank_mask:0xf
  v_and_b32_dpp v19, v30, v11 row_newbcast:6 row_mask:0xf bank_mask:0xf
  s_waitcnt vmcnt(5)
  buffer_load_dwordx4 a[40:43], v6, s[20:23], 0 offen offset:2048 nt
  v_mfma_f32_16x16x32_bf16 v[24:27], v[16:19], a[24:27], v[24:27]
  buffer_load_dwordx4 a[100:103], v56, s[24:27], s42 offen offset:1024 nt
  v_and_b32_dpp v20, v30, v8 row_newbcast:7 row_mask:0xf bank_mask:0xf
  v_and_b32_dpp v21, v30, v9 row_newbcast:7 row_mask:0xf bank_mask:0xf
  v_and_b32_dpp v22, v30, v10 row_newbcast:7 row_mask:0xf bank_mask:0xf
  v_and_b32_dpp v23, v30, v11 row_newbcast:7 row_mask:0xf bank_mask:0xf
  s_waitcnt vmcnt(5)
  buffer_load_dwordx4 a[44:47], v6, s[20:23], 0 offen offset:3072 nt
  v_mfma_f32_16x16x32_bf16 v[24:27], v[20:23], a[28:31], v[24:27]
  v_and_b32_dpp v16, v30, v8 row_newbcast:8 row_mask:0xf bank_mask:0xf
  v_and_b32_dpp v17, v30, v9 row_newbcast:8 row_mask:0xf bank_mask:0xf
  v_and_b32_dpp v18, v30, v10 row_newbcast:8 row_mask:0xf bank_mask:0xf
  v_and_b32_dpp v19, v30, v11 row_newbcast:8 row_mask:0xf bank_mask:0xf
  s_waitcnt vmcnt(5)
  buffer_load_dwordx4 a[48:51], v7, s[20:23], 0 offen offset:0 nt
  v_mfma_f32_16x16x32_bf16 v[24:27], v[16:19], a[32:35], v[24:27]
  buffer_load_dwordx4 a[104:107], v56, s[24:27], s42 offen offset:2048 nt
  v_and_b32_dpp v20, v30, v8 row_newbcast:9 row_mask:0xf bank_mask:0xf
  v_and_b32_dpp v21, v30, v9 row_newbcast:9 row_mask:0xf bank_mask:0xf
  v_and_b32_dpp v22, v30, v10 row_newbcast:9 row_mask:0xf bank_mask:0xf
  v_and_b32_dpp v23, v30, v11 row_newbcast:9 row_mask:0xf bank_mask:0xf
  s_waitcnt vmcnt(5)
  buffer_load_dwordx4 a[52:55], v7, s[20:23], 0 offen offset:1024 nt
  v_mfma_f32_16x16x32_bf16 v[24:27], v[20:23], a[36:39], v[24:27]
  v_and_b32_dpp v16, v30, v8 row_newbcast:10 row_mask:0xf bank_mask:0xf
  v_and_b32_dpp v17, v30, v9 row_newbcast:10 row_mask:0xf bank_mask:0xf
  v_and_b32_dpp v18, v30, v10 row_newbcast:10 row_mask:0xf bank_mask:0xf
  v_and_b32_dpp v19, v30, v11 row_newbcast:10 row_mask:0xf bank_mask:0xf
  s_waitcnt vmcnt(5)
  buffer_load_dwordx4 a[56:59], v7, s[20:23], 0 offen offset:2048 nt
  v_mfma_f32_16x16x32_bf16 v[24:27], v[16:19], a[40:43], v[24:27]
  buffer_load_dwordx4 a[108:111], v56, s[24:27], s42 offen offset:3072 nt
  s_add_u32 s42, s42, 0x1000
  v_and_b32_dpp v20, v30, v8 row_newbcast:11 row_mask:0xf bank_mask:0xf
  v_and_b32_dpp v21, v30, v9 row_newbcast:11 row_mask:0xf bank_mask:0xf
  v_and_b32_dpp v22, v30, v10 row_newbcast:11 row_mask:0xf bank_mask:0xf
  v_and_b32_dpp v23, v30, v11 row_newbcast:11 row_mask:0xf bank_mask:0xf
  s_waitcnt vmcnt(5)
  buffer_load_dwordx4 a[60:63], v7, s[20:23], 0 offen offset:3072 nt
  v_mfma_f32_16x16x32_bf16 v[24:27], v[20:23], a[44:47], v[24:27]
  v_and_b32_dpp v16, v30, v8 row_newbcast:12 row_mask:0xf bank_mask:0xf
  v_and_b32_dpp v17, v30, v9 row_newbcast:12 row_mask:0xf bank_mask:0xf
  v_and_b32_dpp v18, v30, v10 row_newbcast:12 row_mask:0xf bank_mask:0xf
  v_and_b32_dpp v19, v30, v11 row_newbcast:12 row_mask:0xf bank_mask:0xf
  s_waitcnt vmcnt(5)
  buffer_load_dwordx4 v[64:67], v4, s[16:19], s54 offen offset:0 nt
  v_mfma_f32_16x16x32_bf16 v[24:27], v[16:19], a[48:51], v[24:27]
  buffer_load_dwordx4 a[112:115], v56, s[24:27], s42 offen offset:0 nt
  v_and_b32_dpp v20, v30, v8 row_newbcast:13 row_mask:0xf bank_mask:0xf
  v_and_b32_dpp v21, v30, v9 row_newbcast:13 row_mask:0xf bank_mask:0xf
  v_and_b32_dpp v22, v30, v10 row_newbcast:13 row_mask:0xf bank_mask:0xf
  v_and_b32_dpp v23, v30, v11 row_newbcast:13 row_mask:0xf bank_mask:0xf
  s_waitcnt vmcnt(5)
  buffer_load_dwordx4 v[68:71], v4, s[16:19], s54 offen offset:1024 nt
  v_mfma_f32_16x16x32_bf16 v[24:27], v[20:23], a[52:55], v[24:27]
  v_and_b32_dpp v16, v30, v8 row_newbcast:14 row_mask:0xf bank_mask:0xf
  v_and_b32_dpp v17, v30, v9 row_newbcast:14 row_mask:0xf bank_mask:0xf
  v_and_b32_dpp v18, v30, v10 row_newbcast:14 row_mask:0xf bank_mask:0xf
  v_and_b32_dpp v19, v30, v11 row_newbcast:14 row_mask:0xf bank_mask:0xf
  s_waitcnt vmcnt(5)
  buffer_load_dwordx4 v[72:75], v4, s[16:19], s54 offen offset:2048 nt
  v_mfma_f32_16x16x32_bf16 v[24:27], v[16:19], a[56:59], v[24:27]
  buffer_load_dwordx4 a[116:119], v56, s[24:27], s42 offen offset:1024 nt
  v_and_b32_dpp v20, v30, v8 row_newbcast:15 row_mask:0xf bank_mask:0xf
  v_and_b32_dpp v21, v30, v9 row_newbcast:15 row_mask:0xf bank_mask:0xf
  v_and_b32_dpp v22, v30, v10 row_newbcast:15 row_mask:0xf bank_mask:0xf
  v_and_b32_dpp v23, v30, v11 row_newbcast:15 row_mask:0xf bank_mask:0xf
  s_waitcnt vmcnt(5)
  buffer_load_dwordx4 v[76:79], v4, s[16:19], s54 offen offset:3072 nt
  v_mfma_f32_16x16x32_bf16 v[24:27], v[20:23], a[60:63], v[24:27]
  v_mov_b32 v42, 0
  v_mov_b32 v43, 0
  v_mov_b32 v44, 0
  v_mov_b32 v45, 0
  v_mov_b32 v46, 0
  v_mov_b32 v47, 0
  s_waitcnt vmcnt(5)
  buffer_load_dwordx4 v[80:83], v5, s[16:19], s54 offen offset:0 nt
  v_dot2_f32_bf16 v32, v64, v12, 0
  v_dot2_f32_bf16 v32, v65, v13, v32
  v_dot2_f32_bf16 v32, v66, v14, v32
  v_dot2_f32_bf16 v32, v67, v15, v32
  buffer_load_dwordx4 a[120:123], v56, s[24:27], s42 offen offset:2048 nt
  s_waitcnt vmcnt(5)
  buffer_load_dwordx4 v[84:87], v5, s[16:19], s54 offen offset:1024 nt
  v_dot2_f32_bf16 v33, v68, v12, 0
  v_dot2_f32_bf16 v33, v69, v13, v33
  v_dot2_f32_bf16 v33, v70, v14, v33
  v_dot2_f32_bf16 v33, v71, v15, v33
  s_waitcnt vmcnt(5)
  buffer_load_dwordx4 v[88:91], v5, s[16:19], s54 offen offset:2048 nt
  v_dot2_f32_bf16 v34, v72, v12, 0
  v_dot2_f32_bf16 v34, v73, v13, v34
  v_dot2_f32_bf16 v34, v74, v14, v34
  v_dot2_f32_bf16 v34, v75, v15, v34
  buffer_load_dwordx4 a[124:127], v56, s[24:27], s42 offen offset:3072 nt
  s_waitcnt vmcnt(5)
  buffer_load_dwordx4 v[92:95], v5, s[16:19], s54 offen offset:3072 nt
  v_dot2_f32_bf16 v35, v76, v12, 0
  v_dot2_f32_bf16 v35, v77, v13, v35
  v_dot2_f32_bf16 v35, v78, v14, v35
  v_dot2_f32_bf16 v35, v79, v15, v35
  s_waitcnt vmcnt(5)
  buffer_load_dwordx4 v[96:99], v6, s[16:19], s59 offen offset:0 nt
  v_dot2_f32_bf16 v36, v80, v12, 0
  v_dot2_f32_bf16 v36, v81, v13, v36
  v_dot2_f32_bf16 v36, v82, v14, v36
  v_dot2_f32_bf16 v36, v83, v15, v36
  s_waitcnt vmcnt(4)
  buffer_load_dwordx4 v[100:103], v6, s[16:19], s55 offen offset:1024 nt
  v_dot2_f32_bf16 v37, v84, v12, 0
  v_dot2_f32_bf16 v37, v85, v13, v37
  v_dot2_f32_bf16 v37, v86, v14, v37
  v_dot2_f32_bf16 v37, v87, v15, v37
  s_waitcnt vmcnt(4)
  buffer_load_dwordx4 a[0:3], v4, s[20:23], s54 offen offset:0 nt
  v_dot2_f32_bf16 v38, v88, v12, 0
  v_dot2_f32_bf16 v38, v89, v13, v38
  v_dot2_f32_bf16 v38, v90, v14, v38
  v_dot2_f32_bf16 v38, v91, v15, v38
  s_waitcnt vmcnt(3)
  buffer_load_dwordx4 a[4:7], v4, s[20:23], s54 offen offset:1024 nt
  v_dot2_f32_bf16 v39, v92, v12, 0
  v_dot2_f32_bf16 v39, v93, v13, v39
  v_dot2_f32_bf16 v39, v94, v14, v39
  v_dot2_f32_bf16 v39, v95, v15, v39
  s_waitcnt vmcnt(3)
  buffer_load_dwordx4 a[8:11], v4, s[20:23], s54 offen offset:2048 nt
  v_dot2_f32_bf16 v40, v96, v12, 0
  v_dot2_f32_bf16 v40, v97, v13, v40
  v_dot2_f32_bf16 v40, v98, v14, v40
  v_dot2_f32_bf16 v40, v99, v15, v40
  s_waitcnt vmcnt(3)
  buffer_load_dwordx4 a[12:15], v4, s[20:23], s54 offen offset:3072 nt
  v_dot2_f32_bf16 v41, v100, v12, 0
  v_dot2_f32_bf16 v41, v101, v13, v41
  v_dot2_f32_bf16 v41, v102, v14, v41
  v_dot2_f32_bf16 v41, v103, v15, v41
  v_add_f32_dpp v32, v32, v32 row_ror:8 row_mask:0xf bank_mask:0x3
  s_nop 1
  v_add_f32_dpp v32, v40, v40 row_ror:8 row_mask:0xf bank_mask:0xc
  v_add_f32_dpp v33, v33, v33 row_ror:8 row_mask:0xf bank_mask:0x3
  s_nop 1
  v_add_f32_dpp v33, v41, v41 row_ror:8 row_mask:0xf bank_mask:0xc
  v_add_f32_dpp v34, v34, v34 row_ror:8 row_mask:0xf bank_mask:0x3
  s_nop 1
  v_add_f32_dpp v34, v42, v42 row_ror:8 row_mask:0xf bank_mask:0xc
  v_add_f32_dpp v35, v35, v35 row_ror:8 row_mask:0xf bank_mask:0x3
  s_nop 1
  v_add_f32_dpp v35, v43, v43 row_ror:8 row_mask:0xf bank_mask:0xc
  v_add_f32_dpp v36, v36, v36 row_ror:8 row_mask:0xf bank_mask:0x3
  s_nop 1
  v_add_f32_dpp v36, v44, v44 row_ror:8 row_mask:0xf bank_mask:0xc
  v_add_f32_dpp v37, v37, v37 row_ror:8 row_mask:0xf bank_mask:0x3
  s_nop 1
  v_add_f32_dpp v37, v45, v45 row_ror:8 row_mask:0xf bank_mask:0xc
  v_add_f32_dpp v38, v38, v38 row_ror:8 row_mask:0xf bank_mask:0x3
  s_nop 1
  v_add_f32_dpp v38, v46, v46 row_ror:8 row_mask:0xf bank_mask:0xc
  v_add_f32_dpp v39, v39, v39 row_ror:8 row_mask:0xf bank_mask:0x3
  s_nop 1
  v_add_f32_dpp v39, v47, v47 row_ror:8 row_mask:0xf bank_mask:0xc
  v_add_f32_dpp v32, v32, v32 row_half_mirror row_mask:0xf bank_mask:0x5
  s_nop 1
  v_add_f32_dpp v32, v36, v36 row_half_mirror row_mask:0xf bank_mask:0xa
  v_add_f32_dpp v33, v33, v33 row_half_mirror row_mask:0xf bank_mask:0x5
  s_nop 1
  v_add_f32_dpp v33, v37, v37 row_half_mirror row_mask:0xf bank_mask:0xa
  v_add_f32_dpp v34, v34, v34 row_half_mirror row_mask:0xf bank_mask:0x5
  s_nop 1
  v_add_f32_dpp v34, v38, v38 row_half_mirror row_mask:0xf bank_mask:0xa
  v_add_f32_dpp v35, v35, v35 row_half_mirror row_mask:0xf bank_mask:0x5
  s_nop 1
  v_add_f32_dpp v35, v39, v39 row_half_mirror row_mask:0xf bank_mask:0xa
  v_add_f32_dpp v32, v32, v32 quad_perm:[2,3,0,1] row_mask:0xf bank_mask:0xf
  v_add_f32_dpp v33, v33, v33 quad_perm:[2,3,0,1] row_mask:0xf bank_mask:0xf
  v_add_f32_dpp v34, v34, v34 quad_perm:[2,3,0,1] row_mask:0xf bank_mask:0xf
  v_add_f32_dpp v35, v35, v35 quad_perm:[2,3,0,1] row_mask:0xf bank_mask:0xf
  v_cndmask_b32 v32, v32, v34, s[44:45]
  v_cndmask_b32 v33, v33, v35, s[44:45]
  s_nop 0
  v_add_f32_dpp v32, v32, v32 quad_perm:[1,0,3,2] row_mask:0xf bank_mask:0xf
  v_add_f32_dpp v33, v33, v33 quad_perm:[1,0,3,2] row_mask:0xf bank_mask:0xf
  v_cndmask_b32 v32, v32, v33, s[46:47]
  v_cvt_pk_bf16_f32 v32, v32, v32
  v_lshlrev_b32 v32, 16, v32
  v_mul_f32 v32, 0x3db504f3, v32
  v_cvt_pk_bf16_f32 v32, v32, v32
  v_lshlrev_b32 v32, 16, v32
  v_mul_f32 v32, 0x3fb8aa3b, v32
  s_sub_u32 s3, s36, 64
  v_cmp_gt_u32 vcc, s3, v2
  s_nop 1
  v_cndmask_b32 v32, v57, v32, vcc
  v_max_f32 v58, v32, v28
  s_nop 1
  v_max_f32_dpp v58, v58, v58 row_ror:8 row_mask:0xf bank_mask:0xf
  s_nop 1
  v_max_f32_dpp v58, v58, v58 row_ror:4 row_mask:0xf bank_mask:0xf
  s_nop 1
  v_max_f32_dpp v58, v58, v58 row_ror:2 row_mask:0xf bank_mask:0xf
  s_nop 1
  v_max_f32_dpp v58, v58, v58 row_ror:1 row_mask:0xf bank_mask:0xf
  v_mov_b32 v59, v58
  s_nop 1
  v_permlane16_swap_b32 v58, v59
  v_max_f32 v58, v58, v59
  v_mov_b32 v59, v58
  s_nop 1
  v_permlane32_swap_b32 v58, v59
  v_max_f32 v58, v58, v59
  v_sub_f32 v59, v28, v58
  v_sub_f32 v60, v32, v58
  v_exp_f32 v59, v59
  v_exp_f32 v60, v60
  v_mov_b32 v28, v58
  v_cvt_pk_bf16_f32 v30, v60, v60
  v_fma_f32 v29, v29, v59, v60
  v_mul_f32 v24, v24, v59
  v_mul_f32 v25, v25, v59
  v_mul_f32 v26, v26, v59
  v_mul_f32 v27, v27, v59
  v_and_b32_dpp v16, v30, v8 row_newbcast:0 row_mask:0xf bank_mask:0xf
  v_and_b32_dpp v17, v30, v9 row_newbcast:0 row_mask:0xf bank_mask:0xf
  v_and_b32_dpp v18, v30, v10 row_newbcast:0 row_mask:0xf bank_mask:0xf
  v_and_b32_dpp v19, v30, v11 row_newbcast:0 row_mask:0xf bank_mask:0xf
  s_waitcnt vmcnt(3)
  buffer_load_dwordx4 a[16:19], v5, s[20:23], s54 offen offset:0 nt
  v_mfma_f32_16x16x32_bf16 v[24:27], v[16:19], a[0:3], v[24:27]
  v_and_b32_dpp v20, v30, v8 row_newbcast:1 row_mask:0xf bank_mask:0xf
  v_and_b32_dpp v21, v30, v9 row_newbcast:1 row_mask:0xf bank_mask:0xf
  v_and_b32_dpp v22, v30, v10 row_newbcast:1 row_mask:0xf bank_mask:0xf
  v_and_b32_dpp v23, v30, v11 row_newbcast:1 row_mask:0xf bank_mask:0xf
  s_waitcnt vmcnt(3)
  buffer_load_dwordx4 a[20:23], v5, s[20:23], s54 offen offset:1024 nt
  v_mfma_f32_16x16x32_bf16 v[24:27], v[20:23], a[4:7], v[24:27]
  v_and_b32_dpp v16, v30, v8 row_newbcast:2 row_mask:0xf bank_mask:0xf
  v_and_b32_dpp v17, v30, v9 row_newbcast:2 row_mask:0xf bank_mask:0xf
  v_and_b32_dpp v18, v30, v10 row_newbcast:2 row_mask:0xf bank_mask:0xf
  v_and_b32_dpp v19, v30, v11 row_newbcast:2 row_mask:0xf bank_mask:0xf
  s_waitcnt vmcnt(3)
  buffer_load_dwordx4 a[24:27], v5, s[20:23], s54 offen offset:2048 nt
  v_mfma_f32_16x16x32_bf16 v[24:27], v[16:19], a[8:11], v[24:27]
  v_and_b32_dpp v20, v30, v8 row_newbcast:3 row_mask:0xf bank_mask:0xf
  v_and_b32_dpp v21, v30, v9 row_newbcast:3 row_mask:0xf bank_mask:0xf
  v_and_b32_dpp v22, v30, v10 row_newbcast:3 row_mask:0xf bank_mask:0xf
  v_and_b32_dpp v23, v30, v11 row_newbcast:3 row_mask:0xf bank_mask:0xf
  s_waitcnt vmcnt(3)
  buffer_load_dwordx4 a[28:31], v5, s[20:23], s54 offen offset:3072 nt
  v_mfma_f32_16x16x32_bf16 v[24:27], v[20:23], a[12:15], v[24:27]
  v_and_b32_dpp v16, v30, v8 row_newbcast:4 row_mask:0xf bank_mask:0xf
  v_and_b32_dpp v17, v30, v9 row_newbcast:4 row_mask:0xf bank_mask:0xf
  v_and_b32_dpp v18, v30, v10 row_newbcast:4 row_mask:0xf bank_mask:0xf
  v_and_b32_dpp v19, v30, v11 row_newbcast:4 row_mask:0xf bank_mask:0xf
  s_waitcnt vmcnt(3)
  buffer_load_dwordx4 a[32:35], v6, s[20:23], s59 offen offset:0 nt
  v_mfma_f32_16x16x32_bf16 v[24:27], v[16:19], a[16:19], v[24:27]
  v_and_b32_dpp v20, v30, v8 row_newbcast:5 row_mask:0xf bank_mask:0xf
  v_and_b32_dpp v21, v30, v9 row_newbcast:5 row_mask:0xf bank_mask:0xf
  v_and_b32_dpp v22, v30, v10 row_newbcast:5 row_mask:0xf bank_mask:0xf
  v_and_b32_dpp v23, v30, v11 row_newbcast:5 row_mask:0xf bank_mask:0xf
  s_waitcnt vmcnt(3)
  buffer_load_dwordx4 a[36:39], v6, s[20:23], s55 offen offset:1024 nt
  v_mfma_f32_16x16x32_bf16 v[24:27], v[20:23], a[20:23], v[24:27]
  v_and_b32_dpp v16, v30, v8 row_newbcast:6 row_mask:0xf bank_mask:0xf
  v_and_b32_dpp v17, v30, v9 row_newbcast:6 row_mask:0xf bank_mask:0xf
  v_and_b32_dpp v18, v30, v10 row_newbcast:6 row_mask:0xf bank_mask:0xf
  v_and_b32_dpp v19, v30, v11 row_newbcast:6 row_mask:0xf bank_mask:0xf
  s_waitcnt vmcnt(3)
  buffer_load_dwordx4 v[64:67], v4, s[16:19], s56 offen offset:0 nt
  v_mfma_f32_16x16x32_bf16 v[24:27], v[16:19], a[24:27], v[24:27]
  v_and_b32_dpp v20, v30, v8 row_newbcast:7 row_mask:0xf bank_mask:0xf
  v_and_b32_dpp v21, v30, v9 row_newbcast:7 row_mask:0xf bank_mask:0xf
  v_and_b32_dpp v22, v30, v10 row_newbcast:7 row_mask:0xf bank_mask:0xf
  v_and_b32_dpp v23, v30, v11 row_newbcast:7 row_mask:0xf bank_mask:0xf
  s_waitcnt vmcnt(3)
  buffer_load_dwordx4 v[68:71], v4, s[16:19], s56 offen offset:1024 nt
  v_mfma_f32_16x16x32_bf16 v[24:27], v[20:23], a[28:31], v[24:27]
  v_and_b32_dpp v16, v30, v8 row_newbcast:8 row_mask:0xf bank_mask:0xf
  v_and_b32_dpp v17, v30, v9 row_newbcast:8 row_mask:0xf bank_mask:0xf
  v_and_b32_dpp v18, v30, v10 row_newbcast:8 row_mask:0xf bank_mask:0xf
  v_and_b32_dpp v19, v30, v11 row_newbcast:8 row_mask:0xf bank_mask:0xf
  s_waitcnt vmcnt(3)
  buffer_load_dwordx4 v[72:75], v4, s[16:19], s56 offen offset:2048 nt
  v_mfma_f32_16x16x32_bf16 v[24:27], v[16:19], a[32:35], v[24:27]
  v_and_b32_dpp v20, v30, v8 row_newbcast:9 row_mask:0xf bank_mask:0xf
  v_and_b32_dpp v21, v30, v9 row_newbcast:9 row_mask:0xf bank_mask:0xf
  v_and_b32_dpp v22, v30, v10 row_newbcast:9 row_mask:0xf bank_mask:0xf
  v_and_b32_dpp v23, v30, v11 row_newbcast:9 row_mask:0xf bank_mask:0xf
  s_waitcnt vmcnt(3)
  buffer_load_dwordx4 v[76:79], v4, s[16:19], s56 offen offset:3072 nt
  v_mfma_f32_16x16x32_bf16 v[24:27], v[20:23], a[36:39], v[24:27]
  s_mov_b32 s43, 0
  s_nop 6
L_A_loop:
  s_waitcnt vmcnt(3)
  buffer_load_dwordx4 v[80:83], v5, s[16:19], s56 offen offset:0 nt
  v_dot2_f32_bf16 v32, v64, v12, 0
  v_dot2_f32_bf16 v32, v65, v13, v32
  v_dot2_f32_bf16 v32, v66, v14, v32
  v_dot2_f32_bf16 v32, v67, v15, v32
  s_waitcnt vmcnt(3)
  buffer_load_dwordx4 v[84:87], v5, s[16:19], s56 offen offset:1024 nt
  v_dot2_f32_bf16 v33, v68, v12, 0
  v_dot2_f32_bf16 v33, v69, v13, v33
  v_dot2_f32_bf16 v33, v70, v14, v33
  v_dot2_f32_bf16 v33, v71, v15, v33
  s_waitcnt vmcnt(3)
  buffer_load_dwordx4 v[88:91], v5, s[16:19], s56 offen offset:2048 nt
  v_dot2_f32_bf16 v34, v72, v12, 0
  v_dot2_f32_bf16 v34, v73, v13, v34
  v_dot2_f32_bf16 v34, v74, v14, v34
  v_dot2_f32_bf16 v34, v75, v15, v34
  s_waitcnt vmcnt(3)
  buffer_load_dwordx4 v[92:95], v5, s[16:19], s56 offen offset:3072 nt
  v_dot2_f32_bf16 v35, v76, v12, 0
  v_dot2_f32_bf16 v35, v77, v13, v35
  v_dot2_f32_bf16 v35, v78, v14, v35
  v_dot2_f32_bf16 v35, v79, v15, v35
  s_waitcnt vmcnt(3)
  buffer_load_dwordx4 v[96:99], v6, s[16:19], s56 offen offset:0 nt
  v_dot2_f32_bf16 v36, v80, v12, 0
  v_dot2_f32_bf16 v36, v81, v13, v36
  v_dot2_f32_bf16 v36, v82, v14, v36
  v_dot2_f32_bf16 v36, v83, v15, v36
  s_waitcnt vmcnt(3)
  buffer_load_dwordx4 v[100:103], v6, s[16:19], s56 offen offset:1024 nt
  v_dot2_f32_bf16 v37, v84, v12, 0
  v_dot2_f32_bf16 v37, v85, v13, v37
  v_dot2_f32_bf16 v37, v86, v14, v37
  v_dot2_f32_bf16 v37, v87, v15, v37
  s_waitcnt vmcnt(3)
  buffer_load_dwordx4 v[104:107], v6, s[16:19], s56 offen offset:2048 nt
  v_dot2_f32_bf16 v38, v88, v12, 0
  v_dot2_f32_bf16 v38, v89, v13, v38
  v_dot2_f32_bf16 v38, v90, v14, v38
  v_dot2_f32_bf16 v38, v91, v15, v38
  s_waitcnt vmcnt(3)
  buffer_load_dwordx4 v[108:111], v6, s[16:19], s56 offen offset:3072 nt
  v_dot2_f32_bf16 v39, v92, v12, 0
  v_dot2_f32_bf16 v39, v93, v13, v39
  v_dot2_f32_bf16 v39, v94, v14, v39
  v_dot2_f32_bf16 v39, v95, v15, v39
  s_waitcnt vmcnt(3)
  buffer_load_dwordx4 v[112:115], v7, s[16:19], s56 offen offset:0 nt
  v_dot2_f32_bf16 v40, v96, v12, 0
  v_dot2_f32_bf16 v40, v97, v13, v40
  v_dot2_f32_bf16 v40, v98, v14, v40
  v_dot2_f32_bf16 v40, v99, v15, v40
  s_waitcnt vmcnt(3)
  buffer_load_dwordx4 v[116:119], v7, s[16:19], s56 offen offset:1024 nt
  v_dot2_f32_bf16 v41, v100, v12, 0
  v_dot2_f32_bf16 v41, v101, v13, v41
  v_dot2_f32_bf16 v41, v102, v14, v41
  v_dot2_f32_bf16 v41, v103, v15, v41
  v_add_f32_dpp v32, v32, v32 row_ror:8 row_mask:0xf bank_mask:0x3
  s_nop 1
  v_add_f32_dpp v32, v40, v40 row_ror:8 row_mask:0xf bank_mask:0xc
  s_waitcnt vmcnt(3)
  buffer_load_dwordx4 v[120:123], v7, s[16:19], s56 offen offset:2048 nt
  v_dot2_f32_bf16 v42, v104, v12, 0
  v_dot2_f32_bf16 v42, v105, v13, v42
  v_dot2_f32_bf16 v42, v106, v14, v42
  v_dot2_f32_bf16 v42, v107, v15, v42
  v_add_f32_dpp v33, v33, v33 row_ror:8 row_mask:0xf bank_mask:0x3
  s_nop 1
  v_add_f32_dpp v33, v41, v41 row_ror:8 row_mask:0xf bank_mask:0xc
  s_waitcnt vmcnt(3)
  buffer_load_dwordx4 v[124:127], v7, s[16:19], s56 offen offset:3072 nt
  v_dot2_f32_bf16 v43, v108, v12, 0
  v_dot2_f32_bf16 v43, v109, v13, v43
  v_dot2_f32_bf16 v43, v110, v14, v43
  v_dot2_f32_bf16 v43, v111, v15, v43
  v_add_f32_dpp v34, v34, v34 row_ror:8 row_mask:0xf bank_mask:0x3
  s_nop 1
  v_add_f32_dpp v34, v42, v42 row_ror:8 row_mask:0xf bank_mask:0xc
  s_waitcnt vmcnt(3)
  buffer_load_dwordx4 a[0:3], v4, s[20:23], s56 offen offset:0 nt
  v_dot2_f32_bf16 v44, v112, v12, 0
  v_dot2_f32_bf16 v44, v113, v13, v44
  v_dot2_f32_bf16 v44, v114, v14, v44
  v_dot2_f32_bf16 v44, v115, v15, v44
  v_add_f32_dpp v35, v35, v35 row_ror:8 row_mask:0xf bank_mask:0x3
  s_nop 1
  v_add_f32_dpp v35, v43, v43 row_ror:8 row_mask:0xf bank_mask:0xc
  s_waitcnt vmcnt(3)
  buffer_load_dwordx4 a[4:7], v4, s[20:23], s56 offen offset:1024 nt
  v_dot2_f32_bf16 v45, v116, v12, 0
  v_dot2_f32_bf16 v45, v117, v13, v45
  v_dot2_f32_bf16 v45, v118, v14, v45
  v_dot2_f32_bf16 v45, v119, v15, v45
  v_add_f32_dpp v36, v36, v36 row_ror:8 row_mask:0xf bank_mask:0x3
  s_nop 1
  v_add_f32_dpp v36, v44, v44 row_ror:8 row_mask:0xf bank_mask:0xc
  s_waitcnt vmcnt(3)
  buffer_load_dwordx4 a[8:11], v4, s[20:23], s56 offen offset:2048 nt
  v_dot2_f32_bf16 v46, v120, v12, 0
  v_dot2_f32_bf16 v46, v121, v13, v46
  v_dot2_f32_bf16 v46, v122, v14, v46
  v_dot2_f32_bf16 v46, v123, v15, v46
  v_add_f32_dpp v37, v37, v37 row_ror:8 row_mask:0xf bank_mask:0x3
  s_nop 1
  v_add_f32_dpp v37, v45, v45 row_ror:8 row_mask:0xf bank_mask:0xc
  s_waitcnt vmcnt(3)
  buffer_load_dwordx4 a[12:15], v4, s[20:23], s56 offen offset:3072 nt
  v_dot2_f32_bf16 v47, v124, v12, 0
  v_dot2_f32_bf16 v47, v125, v13, v47
  v_dot2_f32_bf16 v47, v126, v14, v47
  v_dot2_f32_bf16 v47, v127, v15, v47
  v_add_f32_dpp v38, v38, v38 row_ror:8 row_mask:0xf bank_mask:0x3
  s_nop 1
  v_add_f32_dpp v38, v46, v46 row_ror:8 row_mask:0xf bank_mask:0xc
  v_add_f32_dpp v39, v39, v39 row_ror:8 row_mask:0xf bank_mask:0x3
  s_nop 1
  v_add_f32_dpp v39, v47, v47 row_ror:8 row_mask:0xf bank_mask:0xc
  v_add_f32_dpp v32, v32, v32 row_half_mirror row_mask:0xf bank_mask:0x5
  s_nop 1
  v_add_f32_dpp v32, v36, v36 row_half_mirror row_mask:0xf bank_mask:0xa
  v_add_f32_dpp v33, v33, v33 row_half_mirror row_mask:0xf bank_mask:0x5
  s_nop 1
  v_add_f32_dpp v33, v37, v37 row_half_mirror row_mask:0xf bank_mask:0xa
  v_add_f32_dpp v34, v34, v34 row_half_mirror row_mask:0xf bank_mask:0x5
  s_nop 1
  v_add_f32_dpp v34, v38, v38 row_half_mirror row_mask:0xf bank_mask:0xa
  v_add_f32_dpp v35, v35, v35 row_half_mirror row_mask:0xf bank_mask:0x5
  s_nop 1
  v_add_f32_dpp v35, v39, v39 row_half_mirror row_mask:0xf bank_mask:0xa
  v_add_f32_dpp v32, v32, v32 quad_perm:[2,3,0,1] row_mask:0xf bank_mask:0xf
  v_add_f32_dpp v33, v33, v33 quad_perm:[2,3,0,1] row_mask:0xf bank_mask:0xf
  v_add_f32_dpp v34, v34, v34 quad_perm:[2,3,0,1] row_mask:0xf bank_mask:0xf
  v_add_f32_dpp v35, v35, v35 quad_perm:[2,3,0,1] row_mask:0xf bank_mask:0xf
  v_cndmask_b32 v32, v32, v34, s[44:45]
  v_cndmask_b32 v33, v33, v35, s[44:45]
  s_nop 0
  v_add_f32_dpp v32, v32, v32 quad_perm:[1,0,3,2] row_mask:0xf bank_mask:0xf
  v_add_f32_dpp v33, v33, v33 quad_perm:[1,0,3,2] row_mask:0xf bank_mask:0xf
  v_cndmask_b32 v32, v32, v33, s[46:47]
  v_cvt_pk_bf16_f32 v32, v32, v32
  v_lshlrev_b32 v32, 16, v32
  v_mul_f32 v32, 0x3db504f3, v32
  v_cvt_pk_bf16_f32 v32, v32, v32
  v_lshlrev_b32 v32, 16, v32
  v_mul_f32 v32, 0x3fb8aa3b, v32
  v_max_f32 v58, v32, v28
  s_nop 1
  v_max_f32_dpp v58, v58, v58 row_ror:8 row_mask:0xf bank_mask:0xf
  s_nop 1
  v_max_f32_dpp v58, v58, v58 row_ror:4 row_mask:0xf bank_mask:0xf
  s_nop 1
  v_max_f32_dpp v58, v58, v58 row_ror:2 row_mask:0xf bank_mask:0xf
  s_nop 1
  v_max_f32_dpp v58, v58, v58 row_ror:1 row_mask:0xf bank_mask:0xf
  v_mov_b32 v59, v58
  s_nop 1
  v_permlane16_swap_b32 v58, v59
  v_max_f32 v58, v58, v59
  v_mov_b32 v59, v58
  s_nop 1
  v_permlane32_swap_b32 v58, v59
  v_max_f32 v58, v58, v59
  v_sub_f32 v59, v28, v58
  v_sub_f32 v60, v32, v58
  v_exp_f32 v59, v59
  v_exp_f32 v60, v60
  v_mov_b32 v28, v58
  v_cvt_pk_bf16_f32 v30, v60, v60
  v_fma_f32 v29, v29, v59, v60
  v_mul_f32 v24, v24, v59
  v_mul_f32 v25, v25, v59
  v_mul_f32 v26, v26, v59
  v_mul_f32 v27, v27, v59
  v_and_b32_dpp v16, v30, v8 row_newbcast:0 row_mask:0xf bank_mask:0xf
  v_and_b32_dpp v17, v30, v9 row_newbcast:0 row_mask:0xf bank_mask:0xf
  v_and_b32_dpp v18, v30, v10 row_newbcast:0 row_mask:0xf bank_mask:0xf
  v_and_b32_dpp v19, v30, v11 row_newbcast:0 row_mask:0xf bank_mask:0xf
  s_waitcnt vmcnt(3)
  buffer_load_dwordx4 a[16:19], v5, s[20:23], s56 offen offset:0 nt
  v_mfma_f32_16x16x32_bf16 v[24:27], v[16:19], a[0:3], v[24:27]
  v_and_b32_dpp v20, v30, v8 row_newbcast:1 row_mask:0xf bank_mask:0xf
  v_and_b32_dpp v21, v30, v9 row_newbcast:1 row_mask:0xf bank_mask:0xf
  v_and_b32_dpp v22, v30, v10 row_newbcast:1 row_mask:0xf bank_mask:0xf
  v_and_b32_dpp v23, v30, v11 row_newbcast:1 row_mask:0xf bank_mask:0xf
  s_waitcnt vmcnt(3)
  buffer_load_dwordx4 a[20:23], v5, s[20:23], s56 offen offset:1024 nt
  v_mfma_f32_16x16x32_bf16 v[24:27], v[20:23], a[4:7], v[24:27]
  v_and_b32_dpp v16, v30, v8 row_newbcast:2 row_mask:0xf bank_mask:0xf
  v_and_b32_dpp v17, v30, v9 row_newbcast:2 row_mask:0xf bank_mask:0xf
  v_and_b32_dpp v18, v30, v10 row_newbcast:2 row_mask:0xf bank_mask:0xf
  v_and_b32_dpp v19, v30, v11 row_newbcast:2 row_mask:0xf bank_mask:0xf
  s_waitcnt vmcnt(3)
  buffer_load_dwordx4 a[24:27], v5, s[20:23], s56 offen offset:2048 nt
  v_mfma_f32_16x16x32_bf16 v[24:27], v[16:19], a[8:11], v[24:27]
  v_and_b32_dpp v20, v30, v8 row_newbcast:3 row_mask:0xf bank_mask:0xf
  v_and_b32_dpp v21, v30, v9 row_newbcast:3 row_mask:0xf bank_mask:0xf
  v_and_b32_dpp v22, v30, v10 row_newbcast:3 row_mask:0xf bank_mask:0xf
  v_and_b32_dpp v23, v30, v11 row_newbcast:3 row_mask:0xf bank_mask:0xf
  s_waitcnt vmcnt(3)
  buffer_load_dwordx4 a[28:31], v5, s[20:23], s56 offen offset:3072 nt
  v_mfma_f32_16x16x32_bf16 v[24:27], v[20:23], a[12:15], v[24:27]
  v_and_b32_dpp v16, v30, v8 row_newbcast:4 row_mask:0xf bank_mask:0xf
  v_and_b32_dpp v17, v30, v9 row_newbcast:4 row_mask:0xf bank_mask:0xf
  v_and_b32_dpp v18, v30, v10 row_newbcast:4 row_mask:0xf bank_mask:0xf
  v_and_b32_dpp v19, v30, v11 row_newbcast:4 row_mask:0xf bank_mask:0xf
  s_waitcnt vmcnt(3)
  buffer_load_dwordx4 a[32:35], v6, s[20:23], s56 offen offset:0 nt
  v_mfma_f32_16x16x32_bf16 v[24:27], v[16:19], a[16:19], v[24:27]
  v_and_b32_dpp v20, v30, v8 row_newbcast:5 row_mask:0xf bank_mask:0xf
  v_and_b32_dpp v21, v30, v9 row_newbcast:5 row_mask:0xf bank_mask:0xf
  v_and_b32_dpp v22, v30, v10 row_newbcast:5 row_mask:0xf bank_mask:0xf
  v_and_b32_dpp v23, v30, v11 row_newbcast:5 row_mask:0xf bank_mask:0xf
  s_waitcnt vmcnt(3)
  buffer_load_dwordx4 a[36:39], v6, s[20:23], s56 offen offset:1024 nt
  v_mfma_f32_16x16x32_bf16 v[24:27], v[20:23], a[20:23], v[24:27]
  v_and_b32_dpp v16, v30, v8 row_newbcast:6 row_mask:0xf bank_mask:0xf
  v_and_b32_dpp v17, v30, v9 row_newbcast:6 row_mask:0xf bank_mask:0xf
  v_and_b32_dpp v18, v30, v10 row_newbcast:6 row_mask:0xf bank_mask:0xf
  v_and_b32_dpp v19, v30, v11 row_newbcast:6 row_mask:0xf bank_mask:0xf
  s_waitcnt vmcnt(3)
  buffer_load_dwordx4 a[40:43], v6, s[20:23], s56 offen offset:2048 nt
  v_mfma_f32_16x16x32_bf16 v[24:27], v[16:19], a[24:27], v[24:27]
  v_and_b32_dpp v20, v30, v8 row_newbcast:7 row_mask:0xf bank_mask:0xf
  v_and_b32_dpp v21, v30, v9 row_newbcast:7 row_mask:0xf bank_mask:0xf
  v_and_b32_dpp v22, v30, v10 row_newbcast:7 row_mask:0xf bank_mask:0xf
  v_and_b32_dpp v23, v30, v11 row_newbcast:7 row_mask:0xf bank_mask:0xf
  s_waitcnt vmcnt(3)
  buffer_load_dwordx4 a[44:47], v6, s[20:23], s56 offen offset:3072 nt
  v_mfma_f32_16x16x32_bf16 v[24:27], v[20:23], a[28:31], v[24:27]
  v_and_b32_dpp v16, v30, v8 row_newbcast:8 row_mask:0xf bank_mask:0xf
  v_and_b32_dpp v17, v30, v9 row_newbcast:8 row_mask:0xf bank_mask:0xf
  v_and_b32_dpp v18, v30, v10 row_newbcast:8 row_mask:0xf bank_mask:0xf
  v_and_b32_dpp v19, v30, v11 row_newbcast:8 row_mask:0xf bank_mask:0xf
  s_waitcnt vmcnt(3)
  buffer_load_dwordx4 a[48:51], v7, s[20:23], s56 offen offset:0 nt
  v_mfma_f32_16x16x32_bf16 v[24:27], v[16:19], a[32:35], v[24:27]
  v_and_b32_dpp v20, v30, v8 row_newbcast:9 row_mask:0xf bank_mask:0xf
  v_and_b32_dpp v21, v30, v9 row_newbcast:9 row_mask:0xf bank_mask:0xf
  v_and_b32_dpp v22, v30, v10 row_newbcast:9 row_mask:0xf bank_mask:0xf
  v_and_b32_dpp v23, v30, v11 row_newbcast:9 row_mask:0xf bank_mask:0xf
  s_waitcnt vmcnt(3)
  buffer_load_dwordx4 a[52:55], v7, s[20:23], s56 offen offset:1024 nt
  v_mfma_f32_16x16x32_bf16 v[24:27], v[20:23], a[36:39], v[24:27]
  v_and_b32_dpp v16, v30, v8 row_newbcast:10 row_mask:0xf bank_mask:0xf
  v_and_b32_dpp v17, v30, v9 row_newbcast:10 row_mask:0xf bank_mask:0xf
  v_and_b32_dpp v18, v30, v10 row_newbcast:10 row_mask:0xf bank_mask:0xf
  v_and_b32_dpp v19, v30, v11 row_newbcast:10 row_mask:0xf bank_mask:0xf
  s_waitcnt vmcnt(3)
  buffer_load_dwordx4 a[56:59], v7, s[20:23], s56 offen offset:2048 nt
  v_mfma_f32_16x16x32_bf16 v[24:27], v[16:19], a[40:43], v[24:27]
  v_and_b32_dpp v20, v30, v8 row_newbcast:11 row_mask:0xf bank_mask:0xf
  v_and_b32_dpp v21, v30, v9 row_newbcast:11 row_mask:0xf bank_mask:0xf
  v_and_b32_dpp v22, v30, v10 row_newbcast:11 row_mask:0xf bank_mask:0xf
  v_and_b32_dpp v23, v30, v11 row_newbcast:11 row_mask:0xf bank_mask:0xf
  s_waitcnt vmcnt(3)
  buffer_load_dwordx4 a[60:63], v7, s[20:23], s56 offen offset:3072 nt
  v_mfma_f32_16x16x32_bf16 v[24:27], v[20:23], a[44:47], v[24:27]
  v_and_b32_dpp v16, v30, v8 row_newbcast:12 row_mask:0xf bank_mask:0xf
  v_and_b32_dpp v17, v30, v9 row_newbcast:12 row_mask:0xf bank_mask:0xf
  v_and_b32_dpp v18, v30, v10 row_newbcast:12 row_mask:0xf bank_mask:0xf
  v_and_b32_dpp v19, v30, v11 row_newbcast:12 row_mask:0xf bank_mask:0xf
  s_waitcnt vmcnt(3)
  buffer_load_dwordx4 v[64:67], v4, s[16:19], s57 offen offset:0 nt
  v_mfma_f32_16x16x32_bf16 v[24:27], v[16:19], a[48:51], v[24:27]
  v_and_b32_dpp v20, v30, v8 row_newbcast:13 row_mask:0xf bank_mask:0xf
  v_and_b32_dpp v21, v30, v9 row_newbcast:13 row_mask:0xf bank_mask:0xf
  v_and_b32_dpp v22, v30, v10 row_newbcast:13 row_mask:0xf bank_mask:0xf
  v_and_b32_dpp v23, v30, v11 row_newbcast:13 row_mask:0xf bank_mask:0xf
  s_waitcnt vmcnt(3)
  buffer_load_dwordx4 v[68:71], v4, s[16:19], s57 offen offset:1024 nt
  v_mfma_f32_16x16x32_bf16 v[24:27], v[20:23], a[52:55], v[24:27]
  v_and_b32_dpp v16, v30, v8 row_newbcast:14 row_mask:0xf bank_mask:0xf
  v_and_b32_dpp v17, v30, v9 row_newbcast:14 row_mask:0xf bank_mask:0xf
  v_and_b32_dpp v18, v30, v10 row_newbcast:14 row_mask:0xf bank_mask:0xf
  v_and_b32_dpp v19, v30, v11 row_newbcast:14 row_mask:0xf bank_mask:0xf
  s_waitcnt vmcnt(3)
  buffer_load_dwordx4 v[72:75], v4, s[16:19], s57 offen offset:2048 nt
  v_mfma_f32_16x16x32_bf16 v[24:27], v[16:19], a[56:59], v[24:27]
  v_and_b32_dpp v20, v30, v8 row_newbcast:15 row_mask:0xf bank_mask:0xf
  v_and_b32_dpp v21, v30, v9 row_newbcast:15 row_mask:0xf bank_mask:0xf
  v_and_b32_dpp v22, v30, v10 row_newbcast:15 row_mask:0xf bank_mask:0xf
  v_and_b32_dpp v23, v30, v11 row_newbcast:15 row_mask:0xf bank_mask:0xf
  s_waitcnt vmcnt(3)
  buffer_load_dwordx4 v[76:79], v4, s[16:19], s57 offen offset:3072 nt
  v_mfma_f32_16x16x32_bf16 v[24:27], v[20:23], a[60:63], v[24:27]
  s_mov_b32 s56, s57
  s_add_u32 s57, s57, 0x4000
  s_add_u32 s43, s43, 1
  s_cmp_lt_u32 s43, 3
  s_nop 3
  s_cbranch_scc1 L_A_loop
  ds_write_b128 v63, v[24:27] offset:8192
  v_add_f32_dpp v29, v29, v29 row_ror:8 row_mask:0xf bank_mask:0xf
  s_nop 1
  v_add_f32_dpp v29, v29, v29 row_ror:4 row_mask:0xf bank_mask:0xf
  s_nop 1
  v_add_f32_dpp v29, v29, v29 row_ror:2 row_mask:0xf bank_mask:0xf
  s_nop 1
  v_add_f32_dpp v29, v29, v29 row_ror:1 row_mask:0xf bank_mask:0xf
  v_mov_b32 v59, v29
  s_nop 1
  v_permlane16_swap_b32 v29, v59
  v_add_f32 v29, v29, v59
  v_mov_b32 v59, v29
  s_nop 1
  v_permlane32_swap_b32 v29, v59
  v_add_f32 v29, v29, v59
  s_lshl_b32 s3, s32, 3
  v_mov_b32 v31, s3
  ds_write_b64 v31, v[28:29] offset:12288
  s_lshl_b32 s3, s38, 8
  v_and_b32 v58, 63, v0
  v_lshl_add_u32 v59, v58, 2, s3
  v_cmp_lt_u32 vcc, 1, v3
  v_mov_b32 v31, 0
  s_waitcnt lgkmcnt(0)
  s_barrier
  s_waitcnt vmcnt(0)
  ds_read_b128 v[64:67], v31 offset:12288
  ds_read_b128 v[68:71], v31 offset:12304
  ds_read_b128 v[72:75], v31 offset:12320
  ds_read_b128 v[76:79], v31 offset:12336
  ds_read2st64_b32 v[80:81], v59 offset0:32 offset1:34
  ds_read2st64_b32 v[82:83], v59 offset0:36 offset1:38
  ds_read2st64_b32 v[84:85], v59 offset0:40 offset1:42
  ds_read2st64_b32 v[86:87], v59 offset0:44 offset1:46
  s_waitcnt lgkmcnt(4)
  v_max3_f32 v32, v64, v66, v68
  v_max3_f32 v33, v72, v74, v76
  v_max_f32 v32, v32, v70
  v_max_f32 v33, v33, v78
  v_max_f32 v34, v32, v33
  v_cndmask_b32 v32, v34, v32, s[52:53]
  v_cndmask_b32 v33, v34, v33, s[52:53]
  v_sub_f32 v64, v64, v32
  v_sub_f32 v66, v66, v32
  v_sub_f32 v68, v68, v32
  v_sub_f32 v70, v70, v32
  v_sub_f32 v72, v72, v33
  v_sub_f32 v74, v74, v33
  v_sub_f32 v76, v76, v33
  v_sub_f32 v78, v78, v33
  v_exp_f32 v64, v64
  v_exp_f32 v66, v66
  v_exp_f32 v68, v68
  v_exp_f32 v70, v70
  v_exp_f32 v72, v72
  v_exp_f32 v74, v74
  v_exp_f32 v76, v76
  v_exp_f32 v78, v78
  s_waitcnt lgkmcnt(0)
  v_mul_f32 v40, v80, v64
  v_fmac_f32 v40, v81, v66
  v_fmac_f32 v40, v82, v68
  v_fmac_f32 v40, v83, v70
  v_mul_f32 v41, v84, v72
  v_fmac_f32 v41, v85, v74
  v_fmac_f32 v41, v86, v76
  v_fmac_f32 v41, v87, v78
  v_fmac_f32 v40, s58, v41
  v_cvt_pk_bf16_f32 v48, v40, v41
  v_mul_f32 v35, v64, v65
  v_fmac_f32 v35, v66, v67
  v_fmac_f32 v35, v68, v69
  v_fmac_f32 v35, v70, v71
  v_mul_f32 v36, v72, v73
  v_fmac_f32 v36, v74, v75
  v_fmac_f32 v36, v76, v77
  v_fmac_f32 v36, v78, v79
  v_fmac_f32 v35, s58, v36
  v_cndmask_b32 v60, v32, v33, vcc
  v_cndmask_b32 v61, v35, v36, vcc
  v_mov_b32_dpp v58, v48 row_newbcast:0 row_mask:0xf bank_mask:0xf
  v_perm_b32 v16, v58, v58, v52
  v_perm_b32 v17, v58, v58, v53
  v_perm_b32 v18, v58, v58, v54
  v_perm_b32 v19, v58, v58, v55
  s_nop 1
  v_mfma_f32_16x16x32_bf16 v[24:27], v[16:19], a[64:67], 0
  v_mov_b32_dpp v59, v48 row_newbcast:1 row_mask:0xf bank_mask:0xf
  v_perm_b32 v20, v59, v59, v52
  v_perm_b32 v21, v59, v59, v53
  v_perm_b32 v22, v59, v59, v54
  v_perm_b32 v23, v59, v59, v55
  s_nop 1
  v_mfma_f32_16x16x32_bf16 v[24:27], v[20:23], a[68:71], v[24:27]
  v_mov_b32_dpp v58, v48 row_newbcast:2 row_mask:0xf bank_mask:0xf
  v_perm_b32 v16, v58, v58, v52
  v_perm_b32 v17, v58, v58, v53
  v_perm_b32 v18, v58, v58, v54
  v_perm_b32 v19, v58, v58, v55
  s_nop 1
  v_mfma_f32_16x16x32_bf16 v[24:27], v[16:19], a[72:75], v[24:27]
  v_mov_b32_dpp v59, v48 row_newbcast:3 row_mask:0xf bank_mask:0xf
  v_perm_b32 v20, v59, v59, v52
  v_perm_b32 v21, v59, v59, v53
  v_perm_b32 v22, v59, v59, v54
  v_perm_b32 v23, v59, v59, v55
  s_nop 1
  v_mfma_f32_16x16x32_bf16 v[24:27], v[20:23], a[76:79], v[24:27]
  v_mov_b32_dpp v58, v48 row_newbcast:4 row_mask:0xf bank_mask:0xf
  v_perm_b32 v16, v58, v58, v52
  v_perm_b32 v17, v58, v58, v53
  v_perm_b32 v18, v58, v58, v54
  v_perm_b32 v19, v58, v58, v55
  s_nop 1
  v_mfma_f32_16x16x32_bf16 v[24:27], v[16:19], a[80:83], v[24:27]
  v_mov_b32_dpp v59, v48 row_newbcast:5 row_mask:0xf bank_mask:0xf
  v_perm_b32 v20, v59, v59, v52
  v_perm_b32 v21, v59, v59, v53
  v_perm_b32 v22, v59, v59, v54
  v_perm_b32 v23, v59, v59, v55
  s_nop 1
  v_mfma_f32_16x16x32_bf16 v[24:27], v[20:23], a[84:87], v[24:27]
  v_mov_b32_dpp v58, v48 row_newbcast:6 row_mask:0xf bank_mask:0xf
  v_perm_b32 v16, v58, v58, v52
  v_perm_b32 v17, v58, v58, v53
  v_perm_b32 v18, v58, v58, v54
  v_perm_b32 v19, v58, v58, v55
  s_nop 1
  v_mfma_f32_16x16x32_bf16 v[24:27], v[16:19], a[88:91], v[24:27]
  v_mov_b32_dpp v59, v48 row_newbcast:7 row_mask:0xf bank_mask:0xf
  v_perm_b32 v20, v59, v59, v52
  v_perm_b32 v21, v59, v59, v53
  v_perm_b32 v22, v59, v59, v54
  v_perm_b32 v23, v59, v59, v55
  s_nop 1
  v_mfma_f32_16x16x32_bf16 v[24:27], v[20:23], a[92:95], v[24:27]
  v_mov_b32_dpp v58, v48 row_newbcast:8 row_mask:0xf bank_mask:0xf
  v_perm_b32 v16, v58, v58, v52
  v_perm_b32 v17, v58, v58, v53
  v_perm_b32 v18, v58, v58, v54
  v_perm_b32 v19, v58, v58, v55
  s_nop 1
  v_mfma_f32_16x16x32_bf16 v[24:27], v[16:19], a[96:99], v[24:27]
  v_mov_b32_dpp v59, v48 row_newbcast:9 row_mask:0xf bank_mask:0xf
  v_perm_b32 v20, v59, v59, v52
  v_perm_b32 v21, v59, v59, v53
  v_perm_b32 v22, v59, v59, v54
  v_perm_b32 v23, v59, v59, v55
  s_nop 1
  v_mfma_f32_16x16x32_bf16 v[24:27], v[20:23], a[100:103], v[24:27]
  v_mov_b32_dpp v58, v48 row_newbcast:10 row_mask:0xf bank_mask:0xf
  v_perm_b32 v16, v58, v58, v52
  v_perm_b32 v17, v58, v58, v53
  v_perm_b32 v18, v58, v58, v54
  v_perm_b32 v19, v58, v58, v55
  s_nop 1
  v_mfma_f32_16x16x32_bf16 v[24:27], v[16:19], a[104:107], v[24:27]
  v_mov_b32_dpp v59, v48 row_newbcast:11 row_mask:0xf bank_mask:0xf
  v_perm_b32 v20, v59, v59, v52
  v_perm_b32 v21, v59, v59, v53
  v_perm_b32 v22, v59, v59, v54
  v_perm_b32 v23, v59, v59, v55
  s_nop 1
  v_mfma_f32_16x16x32_bf16 v[24:27], v[20:23], a[108:111], v[24:27]
  v_mov_b32_dpp v58, v48 row_newbcast:12 row_mask:0xf bank_mask:0xf
  v_perm_b32 v16, v58, v58, v52
  v_perm_b32 v17, v58, v58, v53
  v_perm_b32 v18, v58, v58, v54
  v_perm_b32 v19, v58, v58, v55
  s_nop 1
  v_mfma_f32_16x16x32_bf16 v[24:27], v[16:19], a[112:115], v[24:27]
  v_mov_b32_dpp v59, v48 row_newbcast:13 row_mask:0xf bank_mask:0xf
  v_perm_b32 v20, v59, v59, v52
  v_perm_b32 v21, v59, v59, v53
  v_perm_b32 v22, v59, v59, v54
  v_perm_b32 v23, v59, v59, v55
  s_nop 1
  v_mfma_f32_16x16x32_bf16 v[24:27], v[20:23], a[116:119], v[24:27]
  v_mov_b32_dpp v58, v48 row_newbcast:14 row_mask:0xf bank_mask:0xf
  v_perm_b32 v16, v58, v58, v52
  v_perm_b32 v17, v58, v58, v53
  v_perm_b32 v18, v58, v58, v54
  v_perm_b32 v19, v58, v58, v55
  s_nop 1
  v_mfma_f32_16x16x32_bf16 v[24:27], v[16:19], a[120:123], v[24:27]
  v_mov_b32_dpp v59, v48 row_newbcast:15 row_mask:0xf bank_mask:0xf
  v_perm_b32 v20, v59, v59, v52
  v_perm_b32 v21, v59, v59, v53
  v_perm_b32 v22, v59, v59, v54
  v_perm_b32 v23, v59, v59, v55
  s_nop 1
  v_mfma_f32_16x16x32_bf16 v[24:27], v[20:23], a[124:127], v[24:27]
  s_mov_b32 exec_hi, s52
  s_nop 6
  global_store_dwordx4 v50, v[24:27], s[50:51] sc1
  s_cmp_lg_u32 s32, 0
  s_nop 0
  s_cbranch_scc1 L_A_noml
  s_and_b32 exec_hi, s52, 1
  s_mov_b32 exec_lo, 1
  global_store_dwordx2 v51, v[60:61], s[50:51] sc1
L_A_noml:
  s_endpgm
.p2align 6
L_B_entry:
  s_load_dwordx2 s[4:5], s[0:1], 0
  s_load_dwordx8 s[8:15], s[0:1], 48
  s_load_dwordx4 s[16:19], s[0:1], 80
  s_load_dwordx4 s[52:55], s[0:1], 96
  s_load_dwordx2 s[56:57], s[0:1], 112
  v_lshrrev_b32 v1, 6, v0
  s_nop 0
  v_readfirstlane_b32 s36, v1
  s_and_b32 s40, s2, 7
  s_lshr_b32 s41, s2, 3
  s_lshl_b32 s37, s40, 2
  s_add_u32 s37, s37, s41
  s_lshr_b32 s38, s36, 2
  s_and_b32 s49, s36, 3
  s_lshl_b32 s39, s37, 1
  s_add_u32 s39, s39, s38
  v_and_b32 v1, 63, v0
  v_and_b32 v2, 15, v0
  v_bfe_u32 v3, v0, 4, 2
  v_mov_b32 v4, 0
  s_lshl_b32 s3, s36, 6
  v_lshl_add_u32 v28, v3, 4, s3
  v_add_lshl_u32 v29, v28, v2, 1
  v_lshlrev_b32 v28, 13, v28
  v_lshl_add_u32 v14, v2, 4, v28
  v_add_u32 v28, s3, v3
  v_lshlrev_b32 v28, 13, v28
  v_lshl_add_u32 v31, v2, 4, v28
  s_lshl_b32 s3, s49, 8
  v_lshl_add_u32 v28, v2, 4, s3
  v_lshl_add_u32 v5, v3, 10, v28
  v_lshrrev_b32 v30, 1, v3
  v_lshlrev_b32 v30, 11, v30
  v_lshl_add_u32 v30, v2, 5, v30
  v_and_b32 v36, 1, v3
  v_lshl_add_u32 v30, v36, 4, v30
  s_lshl_b32 s3, s39, 12
  s_lshl_b32 s40, s49, 9
  s_add_u32 s3, s3, s40
  s_add_u32 s3, s3, 6291456
  v_add_u32 v30, s3, v30
  v_mov_b32 v32, -1
  v_mov_b32 v33, -1
  v_mov_b32 v34, -1
  v_mov_b32 v35, -1
  s_lshl_b32 s41, s37, 8
  s_lshl_b32 s40, s39, 18
  s_mov_b32 s42, 0
  s_waitcnt lgkmcnt(0)
  global_store_dwordx4 v30, v[32:35], s[56:57] sc1
  global_load_ushort v12, v29, s[4:5]
  global_load_ushort v13, v29, s[4:5] offset:1024
  s_add_u32 s24, s10, s41
  s_addc_u32 s25, s11, 0
  s_mov_b32 s26, 4186368
  s_mov_b32 s27, 0x00020000
  buffer_load_dwordx4 a[0:3], v14, s[24:27], s42 offen nt
  s_add_u32 s42, s42, 0x2000
  buffer_load_dwordx4 a[4:7], v14, s[24:27], s42 offen nt
  s_add_u32 s42, s42, 0x2000
  buffer_load_dwordx4 a[8:11], v14, s[24:27], s42 offen nt
  s_add_u32 s42, s42, 0x2000
  buffer_load_dwordx4 a[12:15], v14, s[24:27], s42 offen nt
  s_add_u32 s42, s42, 0x2000
  buffer_load_dwordx4 a[16:19], v14, s[24:27], s42 offen nt
  s_add_u32 s42, s42, 0x2000
  buffer_load_dwordx4 a[20:23], v14, s[24:27], s42 offen nt
  s_add_u32 s42, s42, 0x2000
  buffer_load_dwordx4 a[24:27], v14, s[24:27], s42 offen nt
  s_add_u32 s42, s42, 0x2000
  buffer_load_dwordx4 a[28:31], v14, s[24:27], s42 offen nt
  s_add_u32 s42, s42, 0x2000
  buffer_load_dwordx4 a[32:35], v14, s[24:27], s42 offen nt
  s_add_u32 s42, s42, 0x2000
  buffer_load_dwordx4 a[36:39], v14, s[24:27], s42 offen nt
  s_add_u32 s42, s42, 0x2000
  buffer_load_dwordx4 a[40:43], v14, s[24:27], s42 offen nt
  s_add_u32 s42, s42, 0x2000
  buffer_load_dwordx4 a[44:47], v14, s[24:27], s42 offen nt
  s_add_u32 s42, s42, 0x2000
  buffer_load_dwordx4 a[48:51], v14, s[24:27], s42 offen nt
  s_add_u32 s42, s42, 0x2000
  buffer_load_dwordx4 a[52:55], v14, s[24:27], s42 offen nt
  s_add_u32 s42, s42, 0x2000
  buffer_load_dwordx4 a[56:59], v14, s[24:27], s42 offen nt
  s_add_u32 s42, s42, 0x2000
  buffer_load_dwordx4 a[60:63], v14, s[24:27], s42 offen nt
  s_add_u32 s28, s12, s41
  s_addc_u32 s29, s13, 0
  s_mov_b32 s30, 4186368
  s_mov_b32 s31, 0x00020000
  s_mov_b32 s42, 0
  buffer_load_dwordx4 v[64:67], v31, s[28:31], s42 offen nt
  s_add_u32 s42, s42, 0x8000
  buffer_load_dwordx4 v[68:71], v31, s[28:31], s42 offen nt
  s_add_u32 s42, s42, 0x8000
  buffer_load_dwordx4 v[72:75], v31, s[28:31], s42 offen nt
  s_add_u32 s42, s42, 0x8000
  buffer_load_dwordx4 v[76:79], v31, s[28:31], s42 offen nt
  s_add_u32 s42, s42, 0x8000
  buffer_load_dwordx4 v[80:83], v31, s[28:31], s42 offen nt
  s_add_u32 s42, s42, 0x8000
  buffer_load_dwordx4 v[84:87], v31, s[28:31], s42 offen nt
  s_add_u32 s42, s42, 0x8000
  buffer_load_dwordx4 v[88:91], v31, s[28:31], s42 offen nt
  s_add_u32 s42, s42, 0x8000
  buffer_load_dwordx4 v[92:95], v31, s[28:31], s42 offen nt
  s_add_u32 s42, s42, 0x8000
  buffer_load_dwordx4 v[96:99], v31, s[28:31], s42 offen nt
  s_add_u32 s42, s42, 0x8000
  buffer_load_dwordx4 v[100:103], v31, s[28:31], s42 offen nt
  s_add_u32 s42, s42, 0x8000
  buffer_load_dwordx4 v[104:107], v31, s[28:31], s42 offen nt
  s_add_u32 s42, s42, 0x8000
  buffer_load_dwordx4 v[108:111], v31, s[28:31], s42 offen nt
  s_add_u32 s42, s42, 0x8000
  buffer_load_dwordx4 v[112:115], v31, s[28:31], s42 offen nt
  s_add_u32 s42, s42, 0x8000
  buffer_load_dwordx4 v[116:119], v31, s[28:31], s42 offen nt
  s_add_u32 s42, s42, 0x8000
  buffer_load_dwordx4 v[120:123], v31, s[28:31], s42 offen nt
  s_add_u32 s42, s42, 0x8000
  buffer_load_dwordx4 v[124:127], v31, s[28:31], s42 offen nt
  s_add_u32 s32, s8, s40
  s_addc_u32 s33, s9, 0
  s_mov_b32 s34, 262144
  s_mov_b32 s35, 0x00020000
  s_mov_b32 s48, 0
  s_mov_b32 s50, 0x1000
  v_mov_b32 v28, 0x0100
  v_mov_b32 v29, 0x0302
  v_cmp_gt_u32 vcc, 8, v2
  s_nop 1
  v_cndmask_b32 v28, v29, v28, vcc
  v_lshlrev_b32 v29, 16, v28
  v_or_b32 v29, 0x0c0c, v29
  v_or_b32 v28, 0x0c0c0000, v28
  v_and_b32 v30, 1, v2
  v_cmp_eq_u32 vcc, 1, v30
  s_nop 1
  v_cndmask_b32 v28, v28, v29, vcc
  v_bfe_u32 v29, v2, 1, 2
  v_mov_b32 v30, 0x0c0c0c0c
  v_cmp_eq_u32 vcc, 0, v29
  s_nop 1
  v_cndmask_b32 v8, v30, v28, vcc
  v_cmp_eq_u32 vcc, 1, v29
  s_nop 1
  v_cndmask_b32 v9, v30, v28, vcc
  v_cmp_eq_u32 vcc, 2, v29
  s_nop 1
  v_cndmask_b32 v10, v30, v28, vcc
  v_cmp_eq_u32 vcc, 3, v29
  s_nop 1
  v_cndmask_b32 v11, v30, v28, vcc
  s_mov_b32 s44, 0xcccccccc
  s_mov_b32 s45, 0xcccccccc
  s_mov_b32 s46, 0xaaaaaaaa
  s_mov_b32 s47, 0xaaaaaaaa
  v_lshrrev_b32 v28, 1, v3
  v_lshlrev_b32 v28, 9, v28
  v_lshl_add_u32 v28, v2, 5, v28
  v_and_b32 v29, 1, v3
  v_lshl_add_u32 v28, v29, 4, v28
  s_lshl_b32 s3, s36, 10
  s_add_u32 s3, s3, 69632
  v_add_u32 v15, s3, v28
  s_waitcnt vmcnt(32)
  v_lshl_or_b32 v12, v13, 16, v12
  s_waitcnt vmcnt(31)
  s_nop 0
  v_mov_b32_dpp v28, v12 row_newbcast:0 row_mask:0xf bank_mask:0xf
  v_perm_b32 v16, v28, v28, v8
  v_perm_b32 v17, v28, v28, v9
  v_perm_b32 v18, v28, v28, v10
  v_perm_b32 v19, v28, v28, v11
  s_nop 1
  v_mfma_f32_16x16x32_bf16 v[24:27], v[16:19], a[0:3], 0
  s_waitcnt vmcnt(30)
  v_mov_b32_dpp v29, v12 row_newbcast:1 row_mask:0xf bank_mask:0xf
  v_perm_b32 v20, v29, v29, v8
  v_perm_b32 v21, v29, v29, v9
  v_perm_b32 v22, v29, v29, v10
  v_perm_b32 v23, v29, v29, v11
  s_nop 1
  v_mfma_f32_16x16x32_bf16 v[24:27], v[20:23], a[4:7], v[24:27]
  s_waitcnt vmcnt(29)
  v_mov_b32_dpp v28, v12 row_newbcast:2 row_mask:0xf bank_mask:0xf
  v_perm_b32 v16, v28, v28, v8
  v_perm_b32 v17, v28, v28, v9
  v_perm_b32 v18, v28, v28, v10
  v_perm_b32 v19, v28, v28, v11
  s_nop 1
  v_mfma_f32_16x16x32_bf16 v[24:27], v[16:19], a[8:11], v[24:27]
  s_waitcnt vmcnt(28)
  v_mov_b32_dpp v29, v12 row_newbcast:3 row_mask:0xf bank_mask:0xf
  v_perm_b32 v20, v29, v29, v8
  v_perm_b32 v21, v29, v29, v9
  v_perm_b32 v22, v29, v29, v10
  v_perm_b32 v23, v29, v29, v11
  s_nop 1
  v_mfma_f32_16x16x32_bf16 v[24:27], v[20:23], a[12:15], v[24:27]
  s_waitcnt vmcnt(27)
  v_mov_b32_dpp v28, v12 row_newbcast:4 row_mask:0xf bank_mask:0xf
  v_perm_b32 v16, v28, v28, v8
  v_perm_b32 v17, v28, v28, v9
  v_perm_b32 v18, v28, v28, v10
  v_perm_b32 v19, v28, v28, v11
  s_nop 1
  v_mfma_f32_16x16x32_bf16 v[24:27], v[16:19], a[16:19], v[24:27]
  s_waitcnt vmcnt(26)
  v_mov_b32_dpp v29, v12 row_newbcast:5 row_mask:0xf bank_mask:0xf
  v_perm_b32 v20, v29, v29, v8
  v_perm_b32 v21, v29, v29, v9
  v_perm_b32 v22, v29, v29, v10
  v_perm_b32 v23, v29, v29, v11
  s_nop 1
  v_mfma_f32_16x16x32_bf16 v[24:27], v[20:23], a[20:23], v[24:27]
  s_waitcnt vmcnt(25)
  v_mov_b32_dpp v28, v12 row_newbcast:6 row_mask:0xf bank_mask:0xf
  v_perm_b32 v16, v28, v28, v8
  v_perm_b32 v17, v28, v28, v9
  v_perm_b32 v18, v28, v28, v10
  v_perm_b32 v19, v28, v28, v11
  s_nop 1
  v_mfma_f32_16x16x32_bf16 v[24:27], v[16:19], a[24:27], v[24:27]
  s_waitcnt vmcnt(24)
  v_mov_b32_dpp v29, v12 row_newbcast:7 row_mask:0xf bank_mask:0xf
  v_perm_b32 v20, v29, v29, v8
  v_perm_b32 v21, v29, v29, v9
  v_perm_b32 v22, v29, v29, v10
  v_perm_b32 v23, v29, v29, v11
  s_nop 1
  v_mfma_f32_16x16x32_bf16 v[24:27], v[20:23], a[28:31], v[24:27]
  s_waitcnt vmcnt(23)
  v_mov_b32_dpp v28, v12 row_newbcast:8 row_mask:0xf bank_mask:0xf
  v_perm_b32 v16, v28, v28, v8
  v_perm_b32 v17, v28, v28, v9
  v_perm_b32 v18, v28, v28, v10
  v_perm_b32 v19, v28, v28, v11
  s_nop 1
  v_mfma_f32_16x16x32_bf16 v[24:27], v[16:19], a[32:35], v[24:27]
  s_waitcnt vmcnt(22)
  v_mov_b32_dpp v29, v12 row_newbcast:9 row_mask:0xf bank_mask:0xf
  v_perm_b32 v20, v29, v29, v8
  v_perm_b32 v21, v29, v29, v9
  v_perm_b32 v22, v29, v29, v10
  v_perm_b32 v23, v29, v29, v11
  s_nop 1
  v_mfma_f32_16x16x32_bf16 v[24:27], v[20:23], a[36:39], v[24:27]
  s_waitcnt vmcnt(21)
  v_mov_b32_dpp v28, v12 row_newbcast:10 row_mask:0xf bank_mask:0xf
  v_perm_b32 v16, v28, v28, v8
  v_perm_b32 v17, v28, v28, v9
  v_perm_b32 v18, v28, v28, v10
  v_perm_b32 v19, v28, v28, v11
  s_nop 1
  v_mfma_f32_16x16x32_bf16 v[24:27], v[16:19], a[40:43], v[24:27]
  s_waitcnt vmcnt(20)
  v_mov_b32_dpp v29, v12 row_newbcast:11 row_mask:0xf bank_mask:0xf
  v_perm_b32 v20, v29, v29, v8
  v_perm_b32 v21, v29, v29, v9
  v_perm_b32 v22, v29, v29, v10
  v_perm_b32 v23, v29, v29, v11
  s_nop 1
  v_mfma_f32_16x16x32_bf16 v[24:27], v[20:23], a[44:47], v[24:27]
  s_waitcnt vmcnt(19)
  v_mov_b32_dpp v28, v12 row_newbcast:12 row_mask:0xf bank_mask:0xf
  v_perm_b32 v16, v28, v28, v8
  v_perm_b32 v17, v28, v28, v9
  v_perm_b32 v18, v28, v28, v10
  v_perm_b32 v19, v28, v28, v11
  s_nop 1
  v_mfma_f32_16x16x32_bf16 v[24:27], v[16:19], a[48:51], v[24:27]
  s_waitcnt vmcnt(18)
  v_mov_b32_dpp v29, v12 row_newbcast:13 row_mask:0xf bank_mask:0xf
  v_perm_b32 v20, v29, v29, v8
  v_perm_b32 v21, v29, v29, v9
  v_perm_b32 v22, v29, v29, v10
  v_perm_b32 v23, v29, v29, v11
  s_nop 1
  v_mfma_f32_16x16x32_bf16 v[24:27], v[20:23], a[52:55], v[24:27]
  s_waitcnt vmcnt(17)
  v_mov_b32_dpp v28, v12 row_newbcast:14 row_mask:0xf bank_mask:0xf
  v_perm_b32 v16, v28, v28, v8
  v_perm_b32 v17, v28, v28, v9
  v_perm_b32 v18, v28, v28, v10
  v_perm_b32 v19, v28, v28, v11
  s_nop 1
  v_mfma_f32_16x16x32_bf16 v[24:27], v[16:19], a[56:59], v[24:27]
  s_waitcnt vmcnt(16)
  v_mov_b32_dpp v29, v12 row_newbcast:15 row_mask:0xf bank_mask:0xf
  v_perm_b32 v20, v29, v29, v8
  v_perm_b32 v21, v29, v29, v9
  v_perm_b32 v22, v29, v29, v10
  v_perm_b32 v23, v29, v29, v11
  s_nop 1
  v_mfma_f32_16x16x32_bf16 v[24:27], v[20:23], a[60:63], v[24:27]
  s_nop 7
  ds_write_b128 v15, v[24:27]
  buffer_load_dwordx4 a[64:67], v5, s[32:35], s48 offen nt
  s_add_u32 s48, s48, s50
  buffer_load_dwordx4 a[68:71], v5, s[32:35], s48 offen nt
  s_add_u32 s48, s48, s50
  buffer_load_dwordx4 a[72:75], v5, s[32:35], s48 offen nt
  s_add_u32 s48, s48, s50
  buffer_load_dwordx4 a[76:79], v5, s[32:35], s48 offen nt
  s_add_u32 s48, s48, s50
  buffer_load_dwordx4 a[80:83], v5, s[32:35], s48 offen nt
  s_add_u32 s48, s48, s50
  buffer_load_dwordx4 a[84:87], v5, s[32:35], s48 offen nt
  s_add_u32 s48, s48, s50
  buffer_load_dwordx4 a[88:91], v5, s[32:35], s48 offen nt
  s_add_u32 s48, s48, s50
  buffer_load_dwordx4 a[92:95], v5, s[32:35], s48 offen nt
  s_add_u32 s48, s48, s50
  buffer_load_dwordx4 a[96:99], v5, s[32:35], s48 offen nt
  s_add_u32 s48, s48, s50
  buffer_load_dwordx4 a[100:103], v5, s[32:35], s48 offen nt
  s_add_u32 s48, s48, s50
  buffer_load_dwordx4 a[104:107], v5, s[32:35], s48 offen nt
  s_add_u32 s48, s48, s50
  buffer_load_dwordx4 a[108:111], v5, s[32:35], s48 offen nt
  s_add_u32 s48, s48, s50
  buffer_load_dwordx4 a[112:115], v5, s[32:35], s48 offen nt
  s_add_u32 s48, s48, s50
  buffer_load_dwordx4 a[116:119], v5, s[32:35], s48 offen nt
  s_add_u32 s48, s48, s50
  buffer_load_dwordx4 a[120:123], v5, s[32:35], s48 offen nt
  s_add_u32 s48, s48, s50
  buffer_load_dwordx4 a[124:127], v5, s[32:35], s48 offen nt
  s_add_u32 s48, s48, s50
  v_and_b32 v28, 255, v0
  v_lshlrev_b32 v29, 2, v28
  v_add_u32 v29, 69632, v29
  v_lshlrev_b32 v30, 1, v28
  v_add_u32 v30, 77824, v30
  v_lshlrev_b32 v28, 4, v2
  v_add_u32 v28, 77824, v28
  s_waitcnt lgkmcnt(0)
  s_barrier
  ds_read2st64_b32 v[32:33], v29 offset0:0 offset1:4
  ds_read2st64_b32 v[34:35], v29 offset0:8 offset1:12
  ds_read2st64_b32 v[36:37], v29 offset0:16 offset1:20
  ds_read2st64_b32 v[38:39], v29 offset0:24 offset1:28
  s_waitcnt lgkmcnt(0)
  v_pk_add_f32 v[32:33], v[32:33], v[34:35]
  v_pk_add_f32 v[36:37], v[36:37], v[38:39]
  v_pk_add_f32 v[32:33], v[32:33], v[36:37]
  v_add_f32 v32, v32, v33
  v_cvt_pk_bf16_f32 v32, v32, v32
  ds_write_b16 v30, v32
  s_waitcnt lgkmcnt(0)
  s_barrier
  ds_read_b128 v[16:19], v28
  ds_read_b128 v[20:23], v28 offset:256
  s_waitcnt lgkmcnt(0)
  s_waitcnt vmcnt(31)
  v_dot2_f32_bf16 v32, v64, v16, 0
  v_dot2_f32_bf16 v32, v65, v17, v32
  v_dot2_f32_bf16 v32, v66, v18, v32
  v_dot2_f32_bf16 v32, v67, v19, v32
  v_dot2_f32_bf16 v48, v64, v20, 0
  v_dot2_f32_bf16 v48, v65, v21, v48
  v_dot2_f32_bf16 v48, v66, v22, v48
  v_dot2_f32_bf16 v48, v67, v23, v48
  s_waitcnt vmcnt(30)
  v_dot2_f32_bf16 v33, v68, v16, 0
  v_dot2_f32_bf16 v33, v69, v17, v33
  v_dot2_f32_bf16 v33, v70, v18, v33
  v_dot2_f32_bf16 v33, v71, v19, v33
  v_dot2_f32_bf16 v49, v68, v20, 0
  v_dot2_f32_bf16 v49, v69, v21, v49
  v_dot2_f32_bf16 v49, v70, v22, v49
  v_dot2_f32_bf16 v49, v71, v23, v49
  s_waitcnt vmcnt(29)
  v_dot2_f32_bf16 v34, v72, v16, 0
  v_dot2_f32_bf16 v34, v73, v17, v34
  v_dot2_f32_bf16 v34, v74, v18, v34
  v_dot2_f32_bf16 v34, v75, v19, v34
  v_dot2_f32_bf16 v50, v72, v20, 0
  v_dot2_f32_bf16 v50, v73, v21, v50
  v_dot2_f32_bf16 v50, v74, v22, v50
  v_dot2_f32_bf16 v50, v75, v23, v50
  s_waitcnt vmcnt(28)
  v_dot2_f32_bf16 v35, v76, v16, 0
  v_dot2_f32_bf16 v35, v77, v17, v35
  v_dot2_f32_bf16 v35, v78, v18, v35
  v_dot2_f32_bf16 v35, v79, v19, v35
  v_dot2_f32_bf16 v51, v76, v20, 0
  v_dot2_f32_bf16 v51, v77, v21, v51
  v_dot2_f32_bf16 v51, v78, v22, v51
  v_dot2_f32_bf16 v51, v79, v23, v51
  s_waitcnt vmcnt(27)
  v_dot2_f32_bf16 v36, v80, v16, 0
  v_dot2_f32_bf16 v36, v81, v17, v36
  v_dot2_f32_bf16 v36, v82, v18, v36
  v_dot2_f32_bf16 v36, v83, v19, v36
  v_dot2_f32_bf16 v52, v80, v20, 0
  v_dot2_f32_bf16 v52, v81, v21, v52
  v_dot2_f32_bf16 v52, v82, v22, v52
  v_dot2_f32_bf16 v52, v83, v23, v52
  s_waitcnt vmcnt(26)
  v_dot2_f32_bf16 v37, v84, v16, 0
  v_dot2_f32_bf16 v37, v85, v17, v37
  v_dot2_f32_bf16 v37, v86, v18, v37
  v_dot2_f32_bf16 v37, v87, v19, v37
  v_dot2_f32_bf16 v53, v84, v20, 0
  v_dot2_f32_bf16 v53, v85, v21, v53
  v_dot2_f32_bf16 v53, v86, v22, v53
  v_dot2_f32_bf16 v53, v87, v23, v53
  s_waitcnt vmcnt(25)
  v_dot2_f32_bf16 v38, v88, v16, 0
  v_dot2_f32_bf16 v38, v89, v17, v38
  v_dot2_f32_bf16 v38, v90, v18, v38
  v_dot2_f32_bf16 v38, v91, v19, v38
  v_dot2_f32_bf16 v54, v88, v20, 0
  v_dot2_f32_bf16 v54, v89, v21, v54
  v_dot2_f32_bf16 v54, v90, v22, v54
  v_dot2_f32_bf16 v54, v91, v23, v54
  s_waitcnt vmcnt(24)
  v_dot2_f32_bf16 v39, v92, v16, 0
  v_dot2_f32_bf16 v39, v93, v17, v39
  v_dot2_f32_bf16 v39, v94, v18, v39
  v_dot2_f32_bf16 v39, v95, v19, v39
  v_dot2_f32_bf16 v55, v92, v20, 0
  v_dot2_f32_bf16 v55, v93, v21, v55
  v_dot2_f32_bf16 v55, v94, v22, v55
  v_dot2_f32_bf16 v55, v95, v23, v55
  s_waitcnt vmcnt(23)
  v_dot2_f32_bf16 v40, v96, v16, 0
  v_dot2_f32_bf16 v40, v97, v17, v40
  v_dot2_f32_bf16 v40, v98, v18, v40
  v_dot2_f32_bf16 v40, v99, v19, v40
  v_dot2_f32_bf16 v56, v96, v20, 0
  v_dot2_f32_bf16 v56, v97, v21, v56
  v_dot2_f32_bf16 v56, v98, v22, v56
  v_dot2_f32_bf16 v56, v99, v23, v56
  s_waitcnt vmcnt(22)
  v_dot2_f32_bf16 v41, v100, v16, 0
  v_dot2_f32_bf16 v41, v101, v17, v41
  v_dot2_f32_bf16 v41, v102, v18, v41
  v_dot2_f32_bf16 v41, v103, v19, v41
  v_dot2_f32_bf16 v57, v100, v20, 0
  v_dot2_f32_bf16 v57, v101, v21, v57
  v_dot2_f32_bf16 v57, v102, v22, v57
  v_dot2_f32_bf16 v57, v103, v23, v57
  s_waitcnt vmcnt(21)
  v_dot2_f32_bf16 v42, v104, v16, 0
  v_dot2_f32_bf16 v42, v105, v17, v42
  v_dot2_f32_bf16 v42, v106, v18, v42
  v_dot2_f32_bf16 v42, v107, v19, v42
  v_dot2_f32_bf16 v58, v104, v20, 0
  v_dot2_f32_bf16 v58, v105, v21, v58
  v_dot2_f32_bf16 v58, v106, v22, v58
  v_dot2_f32_bf16 v58, v107, v23, v58
  s_waitcnt vmcnt(20)
  v_dot2_f32_bf16 v43, v108, v16, 0
  v_dot2_f32_bf16 v43, v109, v17, v43
  v_dot2_f32_bf16 v43, v110, v18, v43
  v_dot2_f32_bf16 v43, v111, v19, v43
  v_dot2_f32_bf16 v59, v108, v20, 0
  v_dot2_f32_bf16 v59, v109, v21, v59
  v_dot2_f32_bf16 v59, v110, v22, v59
  v_dot2_f32_bf16 v59, v111, v23, v59
  s_waitcnt vmcnt(19)
  v_dot2_f32_bf16 v44, v112, v16, 0
  v_dot2_f32_bf16 v44, v113, v17, v44
  v_dot2_f32_bf16 v44, v114, v18, v44
  v_dot2_f32_bf16 v44, v115, v19, v44
  v_dot2_f32_bf16 v60, v112, v20, 0
  v_dot2_f32_bf16 v60, v113, v21, v60
  v_dot2_f32_bf16 v60, v114, v22, v60
  v_dot2_f32_bf16 v60, v115, v23, v60
  s_waitcnt vmcnt(18)
  v_dot2_f32_bf16 v45, v116, v16, 0
  v_dot2_f32_bf16 v45, v117, v17, v45
  v_dot2_f32_bf16 v45, v118, v18, v45
  v_dot2_f32_bf16 v45, v119, v19, v45
  v_dot2_f32_bf16 v61, v116, v20, 0
  v_dot2_f32_bf16 v61, v117, v21, v61
  v_dot2_f32_bf16 v61, v118, v22, v61
  v_dot2_f32_bf16 v61, v119, v23, v61
  s_waitcnt vmcnt(17)
  v_dot2_f32_bf16 v46, v120, v16, 0
  v_dot2_f32_bf16 v46, v121, v17, v46
  v_dot2_f32_bf16 v46, v122, v18, v46
  v_dot2_f32_bf16 v46, v123, v19, v46
  v_dot2_f32_bf16 v62, v120, v20, 0
  v_dot2_f32_bf16 v62, v121, v21, v62
  v_dot2_f32_bf16 v62, v122, v22, v62
  v_dot2_f32_bf16 v62, v123, v23, v62
  s_waitcnt vmcnt(16)
  v_dot2_f32_bf16 v47, v124, v16, 0
  v_dot2_f32_bf16 v47, v125, v17, v47
  v_dot2_f32_bf16 v47, v126, v18, v47
  v_dot2_f32_bf16 v47, v127, v19, v47
  v_dot2_f32_bf16 v63, v124, v20, 0
  v_dot2_f32_bf16 v63, v125, v21, v63
  v_dot2_f32_bf16 v63, v126, v22, v63
  v_dot2_f32_bf16 v63, v127, v23, v63
  v_add_f32_dpp v32, v32, v32 row_ror:8 row_mask:0xf bank_mask:0x3
  s_nop 1
  v_add_f32_dpp v32, v40, v40 row_ror:8 row_mask:0xf bank_mask:0xc
  v_add_f32_dpp v33, v33, v33 row_ror:8 row_mask:0xf bank_mask:0x3
  s_nop 1
  v_add_f32_dpp v33, v41, v41 row_ror:8 row_mask:0xf bank_mask:0xc
  v_add_f32_dpp v34, v34, v34 row_ror:8 row_mask:0xf bank_mask:0x3
  s_nop 1
  v_add_f32_dpp v34, v42, v42 row_ror:8 row_mask:0xf bank_mask:0xc
  v_add_f32_dpp v35, v35, v35 row_ror:8 row_mask:0xf bank_mask:0x3
  s_nop 1
  v_add_f32_dpp v35, v43, v43 row_ror:8 row_mask:0xf bank_mask:0xc
  v_add_f32_dpp v36, v36, v36 row_ror:8 row_mask:0xf bank_mask:0x3
  s_nop 1
  v_add_f32_dpp v36, v44, v44 row_ror:8 row_mask:0xf bank_mask:0xc
  v_add_f32_dpp v37, v37, v37 row_ror:8 row_mask:0xf bank_mask:0x3
  s_nop 1
  v_add_f32_dpp v37, v45, v45 row_ror:8 row_mask:0xf bank_mask:0xc
  v_add_f32_dpp v38, v38, v38 row_ror:8 row_mask:0xf bank_mask:0x3
  s_nop 1
  v_add_f32_dpp v38, v46, v46 row_ror:8 row_mask:0xf bank_mask:0xc
  v_add_f32_dpp v39, v39, v39 row_ror:8 row_mask:0xf bank_mask:0x3
  s_nop 1
  v_add_f32_dpp v39, v47, v47 row_ror:8 row_mask:0xf bank_mask:0xc
  v_add_f32_dpp v32, v32, v32 row_half_mirror row_mask:0xf bank_mask:0x5
  s_nop 1
  v_add_f32_dpp v32, v36, v36 row_half_mirror row_mask:0xf bank_mask:0xa
  v_add_f32_dpp v33, v33, v33 row_half_mirror row_mask:0xf bank_mask:0x5
  s_nop 1
  v_add_f32_dpp v33, v37, v37 row_half_mirror row_mask:0xf bank_mask:0xa
  v_add_f32_dpp v34, v34, v34 row_half_mirror row_mask:0xf bank_mask:0x5
  s_nop 1
  v_add_f32_dpp v34, v38, v38 row_half_mirror row_mask:0xf bank_mask:0xa
  v_add_f32_dpp v35, v35, v35 row_half_mirror row_mask:0xf bank_mask:0x5
  s_nop 1
  v_add_f32_dpp v35, v39, v39 row_half_mirror row_mask:0xf bank_mask:0xa
  v_add_f32_dpp v32, v32, v32 quad_perm:[2,3,0,1] row_mask:0xf bank_mask:0xf
  v_add_f32_dpp v33, v33, v33 quad_perm:[2,3,0,1] row_mask:0xf bank_mask:0xf
  v_add_f32_dpp v34, v34, v34 quad_perm:[2,3,0,1] row_mask:0xf bank_mask:0xf
  v_add_f32_dpp v35, v35, v35 quad_perm:[2,3,0,1] row_mask:0xf bank_mask:0xf
  v_cndmask_b32 v32, v32, v34, s[44:45]
  v_cndmask_b32 v33, v33, v35, s[44:45]
  s_nop 0
  v_add_f32_dpp v32, v32, v32 quad_perm:[1,0,3,2] row_mask:0xf bank_mask:0xf
  v_add_f32_dpp v33, v33, v33 quad_perm:[1,0,3,2] row_mask:0xf bank_mask:0xf
  v_cndmask_b32 v32, v32, v33, s[46:47]
  v_add_f32_dpp v48, v48, v48 row_ror:8 row_mask:0xf bank_mask:0x3
  s_nop 1
  v_add_f32_dpp v48, v56, v56 row_ror:8 row_mask:0xf bank_mask:0xc
  v_add_f32_dpp v49, v49, v49 row_ror:8 row_mask:0xf bank_mask:0x3
  s_nop 1
  v_add_f32_dpp v49, v57, v57 row_ror:8 row_mask:0xf bank_mask:0xc
  v_add_f32_dpp v50, v50, v50 row_ror:8 row_mask:0xf bank_mask:0x3
  s_nop 1
  v_add_f32_dpp v50, v58, v58 row_ror:8 row_mask:0xf bank_mask:0xc
  v_add_f32_dpp v51, v51, v51 row_ror:8 row_mask:0xf bank_mask:0x3
  s_nop 1
  v_add_f32_dpp v51, v59, v59 row_ror:8 row_mask:0xf bank_mask:0xc
  v_add_f32_dpp v52, v52, v52 row_ror:8 row_mask:0xf bank_mask:0x3
  s_nop 1
  v_add_f32_dpp v52, v60, v60 row_ror:8 row_mask:0xf bank_mask:0xc
  v_add_f32_dpp v53, v53, v53 row_ror:8 row_mask:0xf bank_mask:0x3
  s_nop 1
  v_add_f32_dpp v53, v61, v61 row_ror:8 row_mask:0xf bank_mask:0xc
  v_add_f32_dpp v54, v54, v54 row_ror:8 row_mask:0xf bank_mask:0x3
  s_nop 1
  v_add_f32_dpp v54, v62, v62 row_ror:8 row_mask:0xf bank_mask:0xc
  v_add_f32_dpp v55, v55, v55 row_ror:8 row_mask:0xf bank_mask:0x3
  s_nop 1
  v_add_f32_dpp v55, v63, v63 row_ror:8 row_mask:0xf bank_mask:0xc
  v_add_f32_dpp v48, v48, v48 row_half_mirror row_mask:0xf bank_mask:0x5
  s_nop 1
  v_add_f32_dpp v48, v52, v52 row_half_mirror row_mask:0xf bank_mask:0xa
  v_add_f32_dpp v49, v49, v49 row_half_mirror row_mask:0xf bank_mask:0x5
  s_nop 1
  v_add_f32_dpp v49, v53, v53 row_half_mirror row_mask:0xf bank_mask:0xa
  v_add_f32_dpp v50, v50, v50 row_half_mirror row_mask:0xf bank_mask:0x5
  s_nop 1
  v_add_f32_dpp v50, v54, v54 row_half_mirror row_mask:0xf bank_mask:0xa
  v_add_f32_dpp v51, v51, v51 row_half_mirror row_mask:0xf bank_mask:0x5
  s_nop 1
  v_add_f32_dpp v51, v55, v55 row_half_mirror row_mask:0xf bank_mask:0xa
  v_add_f32_dpp v48, v48, v48 quad_perm:[2,3,0,1] row_mask:0xf bank_mask:0xf
  v_add_f32_dpp v49, v49, v49 quad_perm:[2,3,0,1] row_mask:0xf bank_mask:0xf
  v_add_f32_dpp v50, v50, v50 quad_perm:[2,3,0,1] row_mask:0xf bank_mask:0xf
  v_add_f32_dpp v51, v51, v51 quad_perm:[2,3,0,1] row_mask:0xf bank_mask:0xf
  v_cndmask_b32 v48, v48, v50, s[44:45]
  v_cndmask_b32 v49, v49, v51, s[44:45]
  s_nop 0
  v_add_f32_dpp v48, v48, v48 quad_perm:[1,0,3,2] row_mask:0xf bank_mask:0xf
  v_add_f32_dpp v49, v49, v49 quad_perm:[1,0,3,2] row_mask:0xf bank_mask:0xf
  v_cndmask_b32 v48, v48, v49, s[46:47]
  v_cvt_pk_bf16_f32 v29, v32, v48
  s_lshl_b32 s3, s37, 3
  s_add_u32 s3, s3, s36
  s_lshl_b32 s3, s3, 6
  v_lshl_add_u32 v28, v2, 2, v3
  v_add_lshl_u32 v28, v28, s3, 1
  v_add_u32 v30, 0x8000, v28
  global_store_short v28, v29, s[56:57] sc1
  global_store_short_d16_hi v30, v29, s[56:57] sc1
  s_waitcnt vmcnt(0)
  s_barrier
  s_cmp_lg_u32 s36, 0
  s_cbranch_scc1 L_B_sig1_skip
  s_mov_b64 exec, 1
  v_mov_b32 v28, 1
  global_atomic_add v4, v28, s[54:55] offset:0 sc1
  s_mov_b64 exec, -1
L_B_sig1_skip:
  v_mov_b32 v27, v14
  v_mul_u32_u24 v28, 272, v3
  v_lshl_add_u32 v28, v2, 4, v28
  s_mul_i32 s3, s36, 8704
  v_add_u32 v6, s3, v28
  v_and_b32 v28, 16, v1
  v_and_b32 v29, 3, v1
  v_lshl_add_u32 v28, v29, 2, v28
  v_bfe_u32 v29, v1, 3, 1
  v_lshl_add_u32 v28, v29, 1, v28
  v_bfe_u32 v29, v1, 2, 1
  v_add_u32 v28, v28, v29
  v_mul_u32_u24 v28, 272, v28
  v_lshrrev_b32 v29, 5, v1
  v_lshl_add_u32 v28, v29, 4, v28
  v_add_u32 v7, s3, v28
  v_and_b32 v28, 12, v2
  v_add_u32 v28, v28, v29
  v_mul_u32_u24 v28, 272, v28
  v_and_b32 v30, 1, v3
  v_lshl_add_u32 v28, v30, 5, v28
  v_and_b32 v30, 3, v2
  v_lshl_add_u32 v28, v30, 3, v28
  v_add_u32 v14, s3, v28
  s_lshl_b32 s3, s38, 15
  s_add_u32 s3, s3, 69632
  v_lshlrev_b32 v28, 3, v29
  v_xor_b32 v28, v28, v1
  v_lshl_add_u32 v12, v28, 4, s3
  s_add_u32 s40, s3, 18432
  v_and_b32 v28, 31, v1
  v_lshl_add_u32 v11, v28, 2, s40
  v_and_b32 v28, 7, v1
  s_lshl_b32 s41, s49, 3
  v_add_u32 v28, s41, v28
  v_lshl_add_u32 v10, v28, 2, s40
  v_bfe_u32 v30, v1, 3, 1
  v_lshl_add_u32 v28, v30, 5, v28
  v_and_b32 v30, 8, v1
  v_xor_b32 v28, v28, v30
  v_lshl_add_u32 v28, v28, 4, s3
  v_lshl_add_u32 v8, v3, 10, v28
  v_lshrrev_b32 v30, 1, v3
  v_lshl_add_u32 v28, v30, 10, v28
  v_and_b32 v30, 1, v3
  v_lshl_add_u32 v9, v30, 3, v28
  s_lshl_b32 s3, s49, 12
  v_add_u32 v13, s3, v12
  v_and_b32 v28, 31, v1
  v_lshlrev_b32 v28, 10, v28
  v_lshl_add_u32 v28, v29, 4, v28
  s_lshr_b32 s40, s37, 4
  s_lshl_b32 s40, s40, 15
  s_lshl_b32 s3, s49, 8
  s_add_u32 s3, s3, s40
  v_add_u32 v31, s3, v28
  v_mov_b32 v64, 0
  v_mov_b32 v65, 0
  v_mov_b32 v66, 0
  v_mov_b32 v67, 0
  v_mov_b32 v68, 0
  v_mov_b32 v69, 0
  v_mov_b32 v70, 0
  v_mov_b32 v71, 0
  v_mov_b32 v72, 0
  v_mov_b32 v73, 0
  v_mov_b32 v74, 0
  v_mov_b32 v75, 0
  v_mov_b32 v76, 0
  v_mov_b32 v77, 0
  v_mov_b32 v78, 0
  v_mov_b32 v79, 0
  v_mov_b32 v80, 0
  v_mov_b32 v81, 0
  v_mov_b32 v82, 0
  v_mov_b32 v83, 0
  v_mov_b32 v84, 0
  v_mov_b32 v85, 0
  v_mov_b32 v86, 0
  v_mov_b32 v87, 0
  v_mov_b32 v88, 0
  v_mov_b32 v89, 0
  v_mov_b32 v90, 0
  v_mov_b32 v91, 0
  v_mov_b32 v92, 0
  v_mov_b32 v93, 0
  v_mov_b32 v94, 0
  v_mov_b32 v95, 0
  v_mov_b32 v96, 0
  v_mov_b32 v97, 0
  v_mov_b32 v98, 0
  v_mov_b32 v99, 0
  v_mov_b32 v100, 0
  v_mov_b32 v101, 0
  v_mov_b32 v102, 0
  v_mov_b32 v103, 0
  v_mov_b32 v104, 0
  v_mov_b32 v105, 0
  v_mov_b32 v106, 0
  v_mov_b32 v107, 0
  v_mov_b32 v108, 0
  v_mov_b32 v109, 0
  v_mov_b32 v110, 0
  v_mov_b32 v111, 0
  v_mov_b32 v112, 0
  v_mov_b32 v113, 0
  v_mov_b32 v114, 0
  v_mov_b32 v115, 0
  v_mov_b32 v116, 0
  v_mov_b32 v117, 0
  v_mov_b32 v118, 0
  v_mov_b32 v119, 0
  v_mov_b32 v120, 0
  v_mov_b32 v121, 0
  v_mov_b32 v122, 0
  v_mov_b32 v123, 0
  v_mov_b32 v124, 0
  v_mov_b32 v125, 0
  v_mov_b32 v126, 0
  v_mov_b32 v127, 0
  v_mov_b32 v24, 0xff800000
  v_mov_b32 v25, 0
  s_mov_b32 s43, 0
  ds_write_b128 v6, a[64:67] offset:0
  ds_write_b128 v6, a[68:71] offset:1088
  ds_write_b128 v6, a[72:75] offset:2176
  ds_write_b128 v6, a[76:79] offset:3264
  ds_write_b128 v6, a[80:83] offset:4352
  ds_write_b128 v6, a[84:87] offset:5440
  ds_write_b128 v6, a[88:91] offset:6528
  ds_write_b128 v6, a[92:95] offset:7616
  ds_read_b128 v[48:51], v7 offset:0
  ds_read_b128 v[52:55], v7 offset:32
  ds_read_b128 v[56:59], v7 offset:64
  ds_read_b128 v[60:63], v7 offset:96
  ds_read_b128 a[32:35], v7 offset:128
  ds_read_b128 a[36:39], v7 offset:160
  ds_read_b128 a[40:43], v7 offset:192
  ds_read_b128 a[44:47], v7 offset:224
  s_waitcnt lgkmcnt(0)
  s_cmp_lg_u32 s36, 0
  s_cbranch_scc1 L_B_p1_done
  s_mov_b32 s40, 0
L_B_p1_loop:
  global_load_dword v28, v4, s[54:55] offset:0 sc1
  s_waitcnt vmcnt(0)
  v_readfirstlane_b32 s3, v28
  s_cmp_ge_u32 s3, 32
  s_nop 3
  s_cbranch_scc1 L_B_p1_done
  s_sleep 2
  s_add_u32 s40, s40, 1
  s_cmp_lt_u32 s40, 0x8000
  s_cbranch_scc1 L_B_p1_loop
L_B_p1_done:
  s_barrier
  global_load_dwordx4 a[0:3], v31, s[56:57] offset:0 sc1
  global_load_dwordx4 a[4:7], v31, s[56:57] offset:32 sc1
  global_load_dwordx4 a[8:11], v31, s[56:57] offset:64 sc1
  global_load_dwordx4 a[12:15], v31, s[56:57] offset:96 sc1
  global_load_dwordx4 a[16:19], v31, s[56:57] offset:128 sc1
  global_load_dwordx4 a[20:23], v31, s[56:57] offset:160 sc1
  global_load_dwordx4 a[24:27], v31, s[56:57] offset:192 sc1
  global_load_dwordx4 a[28:31], v31, s[56:57] offset:224 sc1
  buffer_load_dwordx4 a[64:67], v5, s[32:35], s48 offen nt
  s_add_u32 s48, s48, s50
  buffer_load_dwordx4 a[68:71], v5, s[32:35], s48 offen nt
  s_add_u32 s48, s48, s50
  buffer_load_dwordx4 a[72:75], v5, s[32:35], s48 offen nt
  s_add_u32 s48, s48, s50
  buffer_load_dwordx4 a[76:79], v5, s[32:35], s48 offen nt
  s_add_u32 s48, s48, s50
  s_waitcnt vmcnt(4)
L_B_loop:
  v_mfma_f32_32x32x16_bf16 v[32:47], v[48:51], a[0:3], 0
  v_mfma_f32_32x32x16_bf16 v[32:47], v[52:55], a[4:7], v[32:47]
  v_mfma_f32_32x32x16_bf16 v[32:47], v[56:59], a[8:11], v[32:47]
  v_mfma_f32_32x32x16_bf16 v[32:47], v[60:63], a[12:15], v[32:47]
  s_waitcnt lgkmcnt(3)
  v_mfma_f32_32x32x16_bf16 v[32:47], a[32:35], a[16:19], v[32:47]
  s_waitcnt lgkmcnt(2)
  v_mfma_f32_32x32x16_bf16 v[32:47], a[36:39], a[20:23], v[32:47]
  s_waitcnt lgkmcnt(1)
  v_mfma_f32_32x32x16_bf16 v[32:47], a[40:43], a[24:27], v[32:47]
  s_waitcnt lgkmcnt(0)
  v_mfma_f32_32x32x16_bf16 v[32:47], a[44:47], a[28:31], v[32:47]
  buffer_load_dwordx4 a[80:83], v5, s[32:35], s48 offen nt
  s_add_u32 s48, s48, s50
  buffer_load_dwordx4 a[84:87], v5, s[32:35], s48 offen nt
  s_add_u32 s48, s48, s50
  buffer_load_dwordx4 a[88:91], v5, s[32:35], s48 offen nt
  s_add_u32 s48, s48, s50
  buffer_load_dwordx4 a[92:95], v5, s[32:35], s48 offen nt
  s_add_u32 s48, s48, s50
  s_nop 3
  ds_write_b128 v13, v[32:35] offset:0
  ds_write_b128 v13, v[36:39] offset:1024
  ds_write_b128 v13, v[40:43] offset:2048
  ds_write_b128 v13, v[44:47] offset:3072
  s_waitcnt lgkmcnt(0)
  s_barrier
  ds_read_b128 v[32:35], v8 offset:0
  ds_read_b128 v[36:39], v8 offset:4096
  ds_read_b128 v[40:43], v8 offset:8192
  ds_read_b128 v[44:47], v8 offset:12288
  ds_read_b64_tr_b16 a[32:33], v14 offset:0
  ds_read_b64_tr_b16 a[34:35], v14 offset:544
  ds_read_b64_tr_b16 a[36:37], v14 offset:4352
  ds_read_b64_tr_b16 a[38:39], v14 offset:4896
  ds_read_b64_tr_b16 a[40:41], v14 offset:64
  ds_read_b64_tr_b16 a[42:43], v14 offset:608
  ds_read_b64_tr_b16 a[44:45], v14 offset:4416
  ds_read_b64_tr_b16 a[46:47], v14 offset:4960
  s_waitcnt lgkmcnt(10)
  v_pk_add_f32 v[32:33], v[32:33], v[36:37]
  v_pk_add_f32 v[34:35], v[34:35], v[38:39]
  s_waitcnt lgkmcnt(8)
  v_pk_add_f32 v[40:41], v[40:41], v[44:45]
  v_pk_add_f32 v[42:43], v[42:43], v[46:47]
  v_pk_add_f32 v[32:33], v[32:33], v[40:41]
  v_pk_add_f32 v[34:35], v[34:35], v[42:43]
  v_cvt_pk_bf16_f32 v36, v32, v33
  v_cvt_pk_bf16_f32 v37, v34, v35
  v_lshlrev_b32 v32, 16, v36
  v_and_b32 v33, 0xffff0000, v36
  v_lshlrev_b32 v34, 16, v37
  v_and_b32 v35, 0xffff0000, v37
  v_mul_f32 v32, 0x3db504f3, v32
  v_mul_f32 v33, 0x3db504f3, v33
  v_mul_f32 v34, 0x3db504f3, v34
  v_mul_f32 v35, 0x3db504f3, v35
  v_cvt_pk_bf16_f32 v36, v32, v33
  v_cvt_pk_bf16_f32 v37, v34, v35
  v_lshlrev_b32 v32, 16, v36
  v_and_b32 v33, 0xffff0000, v36
  v_lshlrev_b32 v34, 16, v37
  v_and_b32 v35, 0xffff0000, v37
  v_mul_f32 v32, 0x3fb8aa3b, v32
  v_mul_f32 v33, 0x3fb8aa3b, v33
  v_mul_f32 v34, 0x3fb8aa3b, v34
  v_mul_f32 v35, 0x3fb8aa3b, v35
  v_max3_f32 v28, v32, v33, v24
  v_max3_f32 v28, v34, v35, v28
  s_nop 1
  v_max_f32_dpp v28, v28, v28 row_ror:8 row_mask:0xf bank_mask:0xf
  v_mov_b32 v29, v28
  s_nop 1
  v_permlane16_swap_b32 v28, v29
  v_max_f32 v28, v28, v29
  v_mov_b32 v29, v28
  s_nop 1
  v_permlane32_swap_b32 v28, v29
  v_max_f32 v28, v28, v29
  v_sub_f32 v29, v24, v28
  v_sub_f32 v32, v32, v28
  v_sub_f32 v33, v33, v28
  v_sub_f32 v34, v34, v28
  v_sub_f32 v35, v35, v28
  v_exp_f32 v29, v29
  v_exp_f32 v32, v32
  v_exp_f32 v33, v33
  v_exp_f32 v34, v34
  v_exp_f32 v35, v35
  v_mov_b32 v24, v28
  v_cvt_pk_bf16_f32 v36, v32, v33
  v_cvt_pk_bf16_f32 v37, v34, v35
  ds_write_b32 v10, v29
  ds_write_b64 v9, v[36:37] offset:16384
  ds_read_b64_tr_b16 a[48:49], v14 offset:128
  ds_read_b64_tr_b16 a[50:51], v14 offset:672
  ds_read_b64_tr_b16 a[52:53], v14 offset:4480
  ds_read_b64_tr_b16 a[54:55], v14 offset:5024
  ds_read_b64_tr_b16 a[56:57], v14 offset:192
  ds_read_b64_tr_b16 a[58:59], v14 offset:736
  ds_read_b64_tr_b16 a[60:61], v14 offset:4544
  ds_read_b64_tr_b16 a[62:63], v14 offset:5088
  v_pk_add_f32 v[32:33], v[32:33], v[34:35]
  v_fma_f32 v25, v25, v29, v32
  v_add_f32 v25, v25, v33
  s_waitcnt lgkmcnt(8)
  s_barrier
  ds_read_b32 v26, v11
  ds_read_b128 v[16:19], v12 offset:16384
  ds_read_b128 v[20:23], v12 offset:17408
  s_waitcnt vmcnt(8)
  ds_write_b128 v6, a[96:99] offset:0
  ds_write_b128 v6, a[100:103] offset:1088
  ds_write_b128 v6, a[104:107] offset:2176
  ds_write_b128 v6, a[108:111] offset:3264
  ds_write_b128 v6, a[112:115] offset:4352
  ds_write_b128 v6, a[116:119] offset:5440
  ds_write_b128 v6, a[120:123] offset:6528
  ds_write_b128 v6, a[124:127] offset:7616
  ds_read_b128 v[48:51], v7 offset:0
  ds_read_b128 v[52:55], v7 offset:32
  ds_read_b128 v[56:59], v7 offset:64
  ds_read_b128 v[60:63], v7 offset:96
  s_waitcnt lgkmcnt(14)
  v_pk_mul_f32 v[64:65], v[64:65], v[26:27] op_sel_hi:[1,0]
  v_pk_mul_f32 v[66:67], v[66:67], v[26:27] op_sel_hi:[1,0]
  v_pk_mul_f32 v[68:69], v[68:69], v[26:27] op_sel_hi:[1,0]
  v_pk_mul_f32 v[70:71], v[70:71], v[26:27] op_sel_hi:[1,0]
  v_pk_mul_f32 v[72:73], v[72:73], v[26:27] op_sel_hi:[1,0]
  v_pk_mul_f32 v[74:75], v[74:75], v[26:27] op_sel_hi:[1,0]
  v_pk_mul_f32 v[76:77], v[76:77], v[26:27] op_sel_hi:[1,0]
  v_pk_mul_f32 v[78:79], v[78:79], v[26:27] op_sel_hi:[1,0]
  s_waitcnt lgkmcnt(13)
  s_nop 0
  v_mfma_f32_32x32x16_bf16 v[64:79], a[32:35], v[16:19], v[64:79]
  s_waitcnt lgkmcnt(12)
  v_mfma_f32_32x32x16_bf16 v[64:79], a[36:39], v[20:23], v[64:79]
  v_pk_mul_f32 v[80:81], v[80:81], v[26:27] op_sel_hi:[1,0]
  v_pk_mul_f32 v[82:83], v[82:83], v[26:27] op_sel_hi:[1,0]
  v_pk_mul_f32 v[84:85], v[84:85], v[26:27] op_sel_hi:[1,0]
  v_pk_mul_f32 v[86:87], v[86:87], v[26:27] op_sel_hi:[1,0]
  v_pk_mul_f32 v[88:89], v[88:89], v[26:27] op_sel_hi:[1,0]
  v_pk_mul_f32 v[90:91], v[90:91], v[26:27] op_sel_hi:[1,0]
  v_pk_mul_f32 v[92:93], v[92:93], v[26:27] op_sel_hi:[1,0]
  v_pk_mul_f32 v[94:95], v[94:95], v[26:27] op_sel_hi:[1,0]
  s_nop 1
  v_mfma_f32_32x32x16_bf16 v[80:95], a[40:43], v[16:19], v[80:95]
  v_mfma_f32_32x32x16_bf16 v[80:95], a[44:47], v[20:23], v[80:95]
  v_pk_mul_f32 v[96:97], v[96:97], v[26:27] op_sel_hi:[1,0]
  v_pk_mul_f32 v[98:99], v[98:99], v[26:27] op_sel_hi:[1,0]
  v_pk_mul_f32 v[100:101], v[100:101], v[26:27] op_sel_hi:[1,0]
  v_pk_mul_f32 v[102:103], v[102:103], v[26:27] op_sel_hi:[1,0]
  v_pk_mul_f32 v[104:105], v[104:105], v[26:27] op_sel_hi:[1,0]
  v_pk_mul_f32 v[106:107], v[106:107], v[26:27] op_sel_hi:[1,0]
  v_pk_mul_f32 v[108:109], v[108:109], v[26:27] op_sel_hi:[1,0]
  v_pk_mul_f32 v[110:111], v[110:111], v[26:27] op_sel_hi:[1,0]
  s_nop 1
  v_mfma_f32_32x32x16_bf16 v[96:111], a[48:51], v[16:19], v[96:111]
  v_mfma_f32_32x32x16_bf16 v[96:111], a[52:55], v[20:23], v[96:111]
  ds_read_b128 a[32:35], v7 offset:128
  ds_read_b128 a[36:39], v7 offset:160
  ds_read_b128 a[40:43], v7 offset:192
  ds_read_b128 a[44:47], v7 offset:224
  v_pk_mul_f32 v[112:113], v[112:113], v[26:27] op_sel_hi:[1,0]
  v_pk_mul_f32 v[114:115], v[114:115], v[26:27] op_sel_hi:[1,0]
  v_pk_mul_f32 v[116:117], v[116:117], v[26:27] op_sel_hi:[1,0]
  v_pk_mul_f32 v[118:119], v[118:119], v[26:27] op_sel_hi:[1,0]
  v_pk_mul_f32 v[120:121], v[120:121], v[26:27] op_sel_hi:[1,0]
  v_pk_mul_f32 v[122:123], v[122:123], v[26:27] op_sel_hi:[1,0]
  v_pk_mul_f32 v[124:125], v[124:125], v[26:27] op_sel_hi:[1,0]
  v_pk_mul_f32 v[126:127], v[126:127], v[26:27] op_sel_hi:[1,0]
  s_nop 1
  v_mfma_f32_32x32x16_bf16 v[112:127], a[56:59], v[16:19], v[112:127]
  v_mfma_f32_32x32x16_bf16 v[112:127], a[60:63], v[20:23], v[112:127]
  s_waitcnt lgkmcnt(4)
  buffer_load_dwordx4 a[96:99], v5, s[32:35], s48 offen nt
  s_add_u32 s48, s48, s50
  buffer_load_dwordx4 a[100:103], v5, s[32:35], s48 offen nt
  s_add_u32 s48, s48, s50
  buffer_load_dwordx4 a[104:107], v5, s[32:35], s48 offen nt
  s_add_u32 s48, s48, s50
  buffer_load_dwordx4 a[108:111], v5, s[32:35], s48 offen nt
  s_add_u32 s48, s48, s50
  v_mfma_f32_32x32x16_bf16 v[32:47], v[48:51], a[0:3], 0
  v_mfma_f32_32x32x16_bf16 v[32:47], v[52:55], a[4:7], v[32:47]
  v_mfma_f32_32x32x16_bf16 v[32:47], v[56:59], a[8:11], v[32:47]
  v_mfma_f32_32x32x16_bf16 v[32:47], v[60:63], a[12:15], v[32:47]
  s_waitcnt lgkmcnt(3)
  v_mfma_f32_32x32x16_bf16 v[32:47], a[32:35], a[16:19], v[32:47]
  s_waitcnt lgkmcnt(2)
  v_mfma_f32_32x32x16_bf16 v[32:47], a[36:39], a[20:23], v[32:47]
  s_waitcnt lgkmcnt(1)
  v_mfma_f32_32x32x16_bf16 v[32:47], a[40:43], a[24:27], v[32:47]
  s_waitcnt lgkmcnt(0)
  v_mfma_f32_32x32x16_bf16 v[32:47], a[44:47], a[28:31], v[32:47]
  buffer_load_dwordx4 a[112:115], v5, s[32:35], s48 offen nt
  s_add_u32 s48, s48, s50
  buffer_load_dwordx4 a[116:119], v5, s[32:35], s48 offen nt
  s_add_u32 s48, s48, s50
  buffer_load_dwordx4 a[120:123], v5, s[32:35], s48 offen nt
  s_add_u32 s48, s48, s50
  buffer_load_dwordx4 a[124:127], v5, s[32:35], s48 offen nt
  s_add_u32 s48, s48, s50
  s_nop 3
  ds_write_b128 v13, v[32:35] offset:0
  ds_write_b128 v13, v[36:39] offset:1024
  ds_write_b128 v13, v[40:43] offset:2048
  ds_write_b128 v13, v[44:47] offset:3072
  s_waitcnt lgkmcnt(0)
  s_barrier
  ds_read_b128 v[32:35], v8 offset:0
  ds_read_b128 v[36:39], v8 offset:4096
  ds_read_b128 v[40:43], v8 offset:8192
  ds_read_b128 v[44:47], v8 offset:12288
  ds_read_b64_tr_b16 a[32:33], v14 offset:0
  ds_read_b64_tr_b16 a[34:35], v14 offset:544
  ds_read_b64_tr_b16 a[36:37], v14 offset:4352
  ds_read_b64_tr_b16 a[38:39], v14 offset:4896
  ds_read_b64_tr_b16 a[40:41], v14 offset:64
  ds_read_b64_tr_b16 a[42:43], v14 offset:608
  ds_read_b64_tr_b16 a[44:45], v14 offset:4416
  ds_read_b64_tr_b16 a[46:47], v14 offset:4960
  s_cmp_lg_u32 s43, 2
  s_cbranch_scc1 L_B_nosw
  s_lshl_b32 s41, s37, 8
  s_add_u32 s32, s14, s41
  s_addc_u32 s33, s15, 0
  s_mov_b32 s34, 4186368
  s_mov_b32 s35, 0x00020000
  v_swap_b32 v5, v27
  s_mov_b32 s48, 0
  s_mov_b32 s50, 0x2000
L_B_nosw:
  s_waitcnt lgkmcnt(10)
  v_pk_add_f32 v[32:33], v[32:33], v[36:37]
  v_pk_add_f32 v[34:35], v[34:35], v[38:39]
  s_waitcnt lgkmcnt(8)
  v_pk_add_f32 v[40:41], v[40:41], v[44:45]
  v_pk_add_f32 v[42:43], v[42:43], v[46:47]
  v_pk_add_f32 v[32:33], v[32:33], v[40:41]
  v_pk_add_f32 v[34:35], v[34:35], v[42:43]
  v_cvt_pk_bf16_f32 v36, v32, v33
  v_cvt_pk_bf16_f32 v37, v34, v35
  v_lshlrev_b32 v32, 16, v36
  v_and_b32 v33, 0xffff0000, v36
  v_lshlrev_b32 v34, 16, v37
  v_and_b32 v35, 0xffff0000, v37
  v_mul_f32 v32, 0x3db504f3, v32
  v_mul_f32 v33, 0x3db504f3, v33
  v_mul_f32 v34, 0x3db504f3, v34
  v_mul_f32 v35, 0x3db504f3, v35
  v_cvt_pk_bf16_f32 v36, v32, v33
  v_cvt_pk_bf16_f32 v37, v34, v35
  v_lshlrev_b32 v32, 16, v36
  v_and_b32 v33, 0xffff0000, v36
  v_lshlrev_b32 v34, 16, v37
  v_and_b32 v35, 0xffff0000, v37
  v_mul_f32 v32, 0x3fb8aa3b, v32
  v_mul_f32 v33, 0x3fb8aa3b, v33
  v_mul_f32 v34, 0x3fb8aa3b, v34
  v_mul_f32 v35, 0x3fb8aa3b, v35
  v_max3_f32 v28, v32, v33, v24
  v_max3_f32 v28, v34, v35, v28
  s_nop 1
  v_max_f32_dpp v28, v28, v28 row_ror:8 row_mask:0xf bank_mask:0xf
  v_mov_b32 v29, v28
  s_nop 1
  v_permlane16_swap_b32 v28, v29
  v_max_f32 v28, v28, v29
  v_mov_b32 v29, v28
  s_nop 1
  v_permlane32_swap_b32 v28, v29
  v_max_f32 v28, v28, v29
  v_sub_f32 v29, v24, v28
  v_sub_f32 v32, v32, v28
  v_sub_f32 v33, v33, v28
  v_sub_f32 v34, v34, v28
  v_sub_f32 v35, v35, v28
  v_exp_f32 v29, v29
  v_exp_f32 v32, v32
  v_exp_f32 v33, v33
  v_exp_f32 v34, v34
  v_exp_f32 v35, v35
  v_mov_b32 v24, v28
  v_cvt_pk_bf16_f32 v36, v32, v33
  v_cvt_pk_bf16_f32 v37, v34, v35
  ds_write_b32 v10, v29
  ds_write_b64 v9, v[36:37] offset:16384
  ds_read_b64_tr_b16 a[48:49], v14 offset:128
  ds_read_b64_tr_b16 a[50:51], v14 offset:672
  ds_read_b64_tr_b16 a[52:53], v14 offset:4480
  ds_read_b64_tr_b16 a[54:55], v14 offset:5024
  ds_read_b64_tr_b16 a[56:57], v14 offset:192
  ds_read_b64_tr_b16 a[58:59], v14 offset:736
  ds_read_b64_tr_b16 a[60:61], v14 offset:4544
  ds_read_b64_tr_b16 a[62:63], v14 offset:5088
  v_pk_add_f32 v[32:33], v[32:33], v[34:35]
  v_fma_f32 v25, v25, v29, v32
  v_add_f32 v25, v25, v33
  s_waitcnt lgkmcnt(8)
  s_barrier
  ds_read_b32 v26, v11
  ds_read_b128 v[16:19], v12 offset:16384
  ds_read_b128 v[20:23], v12 offset:17408
  s_waitcnt vmcnt(8)
  ds_write_b128 v6, a[64:67] offset:0
  ds_write_b128 v6, a[68:71] offset:1088
  ds_write_b128 v6, a[72:75] offset:2176
  ds_write_b128 v6, a[76:79] offset:3264
  ds_write_b128 v6, a[80:83] offset:4352
  ds_write_b128 v6, a[84:87] offset:5440
  ds_write_b128 v6, a[88:91] offset:6528
  ds_write_b128 v6, a[92:95] offset:7616
  ds_read_b128 v[48:51], v7 offset:0
  ds_read_b128 v[52:55], v7 offset:32
  ds_read_b128 v[56:59], v7 offset:64
  ds_read_b128 v[60:63], v7 offset:96
  s_waitcnt lgkmcnt(14)
  v_pk_mul_f32 v[64:65], v[64:65], v[26:27] op_sel_hi:[1,0]
  v_pk_mul_f32 v[66:67], v[66:67], v[26:27] op_sel_hi:[1,0]
  v_pk_mul_f32 v[68:69], v[68:69], v[26:27] op_sel_hi:[1,0]
  v_pk_mul_f32 v[70:71], v[70:71], v[26:27] op_sel_hi:[1,0]
  v_pk_mul_f32 v[72:73], v[72:73], v[26:27] op_sel_hi:[1,0]
  v_pk_mul_f32 v[74:75], v[74:75], v[26:27] op_sel_hi:[1,0]
  v_pk_mul_f32 v[76:77], v[76:77], v[26:27] op_sel_hi:[1,0]
  v_pk_mul_f32 v[78:79], v[78:79], v[26:27] op_sel_hi:[1,0]
  s_waitcnt lgkmcnt(13)
  s_nop 0
  v_mfma_f32_32x32x16_bf16 v[64:79], a[32:35], v[16:19], v[64:79]
  s_waitcnt lgkmcnt(12)
  v_mfma_f32_32x32x16_bf16 v[64:79], a[36:39], v[20:23], v[64:79]
  v_pk_mul_f32 v[80:81], v[80:81], v[26:27] op_sel_hi:[1,0]
  v_pk_mul_f32 v[82:83], v[82:83], v[26:27] op_sel_hi:[1,0]
  v_pk_mul_f32 v[84:85], v[84:85], v[26:27] op_sel_hi:[1,0]
  v_pk_mul_f32 v[86:87], v[86:87], v[26:27] op_sel_hi:[1,0]
  v_pk_mul_f32 v[88:89], v[88:89], v[26:27] op_sel_hi:[1,0]
  v_pk_mul_f32 v[90:91], v[90:91], v[26:27] op_sel_hi:[1,0]
  v_pk_mul_f32 v[92:93], v[92:93], v[26:27] op_sel_hi:[1,0]
  v_pk_mul_f32 v[94:95], v[94:95], v[26:27] op_sel_hi:[1,0]
  s_nop 1
  v_mfma_f32_32x32x16_bf16 v[80:95], a[40:43], v[16:19], v[80:95]
  v_mfma_f32_32x32x16_bf16 v[80:95], a[44:47], v[20:23], v[80:95]
  v_pk_mul_f32 v[96:97], v[96:97], v[26:27] op_sel_hi:[1,0]
  v_pk_mul_f32 v[98:99], v[98:99], v[26:27] op_sel_hi:[1,0]
  v_pk_mul_f32 v[100:101], v[100:101], v[26:27] op_sel_hi:[1,0]
  v_pk_mul_f32 v[102:103], v[102:103], v[26:27] op_sel_hi:[1,0]
  v_pk_mul_f32 v[104:105], v[104:105], v[26:27] op_sel_hi:[1,0]
  v_pk_mul_f32 v[106:107], v[106:107], v[26:27] op_sel_hi:[1,0]
  v_pk_mul_f32 v[108:109], v[108:109], v[26:27] op_sel_hi:[1,0]
  v_pk_mul_f32 v[110:111], v[110:111], v[26:27] op_sel_hi:[1,0]
  s_nop 1
  v_mfma_f32_32x32x16_bf16 v[96:111], a[48:51], v[16:19], v[96:111]
  v_mfma_f32_32x32x16_bf16 v[96:111], a[52:55], v[20:23], v[96:111]
  ds_read_b128 a[32:35], v7 offset:128
  ds_read_b128 a[36:39], v7 offset:160
  ds_read_b128 a[40:43], v7 offset:192
  ds_read_b128 a[44:47], v7 offset:224
  v_pk_mul_f32 v[112:113], v[112:113], v[26:27] op_sel_hi:[1,0]
  v_pk_mul_f32 v[114:115], v[114:115], v[26:27] op_sel_hi:[1,0]
  v_pk_mul_f32 v[116:117], v[116:117], v[26:27] op_sel_hi:[1,0]
  v_pk_mul_f32 v[118:119], v[118:119], v[26:27] op_sel_hi:[1,0]
  v_pk_mul_f32 v[120:121], v[120:121], v[26:27] op_sel_hi:[1,0]
  v_pk_mul_f32 v[122:123], v[122:123], v[26:27] op_sel_hi:[1,0]
  v_pk_mul_f32 v[124:125], v[124:125], v[26:27] op_sel_hi:[1,0]
  v_pk_mul_f32 v[126:127], v[126:127], v[26:27] op_sel_hi:[1,0]
  s_nop 1
  v_mfma_f32_32x32x16_bf16 v[112:127], a[56:59], v[16:19], v[112:127]
  v_mfma_f32_32x32x16_bf16 v[112:127], a[60:63], v[20:23], v[112:127]
  s_waitcnt lgkmcnt(4)
  buffer_load_dwordx4 a[64:67], v5, s[32:35], s48 offen nt
  s_add_u32 s48, s48, s50
  buffer_load_dwordx4 a[68:71], v5, s[32:35], s48 offen nt
  s_add_u32 s48, s48, s50
  buffer_load_dwordx4 a[72:75], v5, s[32:35], s48 offen nt
  s_add_u32 s48, s48, s50
  buffer_load_dwordx4 a[76:79], v5, s[32:35], s48 offen nt
  s_add_u32 s48, s48, s50
  s_add_u32 s43, s43, 1
  s_cmp_lt_u32 s43, 3
  s_nop 0
  s_cbranch_scc1 L_B_loop
  v_mfma_f32_32x32x16_bf16 v[32:47], v[48:51], a[0:3], 0
  v_mfma_f32_32x32x16_bf16 v[32:47], v[52:55], a[4:7], v[32:47]
  v_mfma_f32_32x32x16_bf16 v[32:47], v[56:59], a[8:11], v[32:47]
  v_mfma_f32_32x32x16_bf16 v[32:47], v[60:63], a[12:15], v[32:47]
  s_waitcnt lgkmcnt(3)
  v_mfma_f32_32x32x16_bf16 v[32:47], a[32:35], a[16:19], v[32:47]
  s_waitcnt lgkmcnt(2)
  v_mfma_f32_32x32x16_bf16 v[32:47], a[36:39], a[20:23], v[32:47]
  s_waitcnt lgkmcnt(1)
  v_mfma_f32_32x32x16_bf16 v[32:47], a[40:43], a[24:27], v[32:47]
  s_waitcnt lgkmcnt(0)
  v_mfma_f32_32x32x16_bf16 v[32:47], a[44:47], a[28:31], v[32:47]
  buffer_load_dwordx4 a[80:83], v5, s[32:35], s48 offen nt
  s_add_u32 s48, s48, s50
  buffer_load_dwordx4 a[84:87], v5, s[32:35], s48 offen nt
  s_add_u32 s48, s48, s50
  buffer_load_dwordx4 a[88:91], v5, s[32:35], s48 offen nt
  s_add_u32 s48, s48, s50
  buffer_load_dwordx4 a[92:95], v5, s[32:35], s48 offen nt
  s_add_u32 s48, s48, s50
  s_nop 3
  ds_write_b128 v13, v[32:35] offset:0
  ds_write_b128 v13, v[36:39] offset:1024
  ds_write_b128 v13, v[40:43] offset:2048
  ds_write_b128 v13, v[44:47] offset:3072
  s_waitcnt lgkmcnt(0)
  s_barrier
  ds_read_b128 v[32:35], v8 offset:0
  ds_read_b128 v[36:39], v8 offset:4096
  ds_read_b128 v[40:43], v8 offset:8192
  ds_read_b128 v[44:47], v8 offset:12288
  ds_read_b64_tr_b16 a[32:33], v14 offset:0
  ds_read_b64_tr_b16 a[34:35], v14 offset:544
  ds_read_b64_tr_b16 a[36:37], v14 offset:4352
  ds_read_b64_tr_b16 a[38:39], v14 offset:4896
  ds_read_b64_tr_b16 a[40:41], v14 offset:64
  ds_read_b64_tr_b16 a[42:43], v14 offset:608
  ds_read_b64_tr_b16 a[44:45], v14 offset:4416
  ds_read_b64_tr_b16 a[46:47], v14 offset:4960
  s_waitcnt lgkmcnt(10)
  v_pk_add_f32 v[32:33], v[32:33], v[36:37]
  v_pk_add_f32 v[34:35], v[34:35], v[38:39]
  s_waitcnt lgkmcnt(8)
  v_pk_add_f32 v[40:41], v[40:41], v[44:45]
  v_pk_add_f32 v[42:43], v[42:43], v[46:47]
  v_pk_add_f32 v[32:33], v[32:33], v[40:41]
  v_pk_add_f32 v[34:35], v[34:35], v[42:43]
  v_cvt_pk_bf16_f32 v36, v32, v33
  v_cvt_pk_bf16_f32 v37, v34, v35
  v_lshlrev_b32 v32, 16, v36
  v_and_b32 v33, 0xffff0000, v36
  v_lshlrev_b32 v34, 16, v37
  v_and_b32 v35, 0xffff0000, v37
  v_mul_f32 v32, 0x3db504f3, v32
  v_mul_f32 v33, 0x3db504f3, v33
  v_mul_f32 v34, 0x3db504f3, v34
  v_mul_f32 v35, 0x3db504f3, v35
  v_cvt_pk_bf16_f32 v36, v32, v33
  v_cvt_pk_bf16_f32 v37, v34, v35
  v_lshlrev_b32 v32, 16, v36
  v_and_b32 v33, 0xffff0000, v36
  v_lshlrev_b32 v34, 16, v37
  v_and_b32 v35, 0xffff0000, v37
  v_mul_f32 v32, 0x3fb8aa3b, v32
  v_mul_f32 v33, 0x3fb8aa3b, v33
  v_mul_f32 v34, 0x3fb8aa3b, v34
  v_mul_f32 v35, 0x3fb8aa3b, v35
  v_max3_f32 v28, v32, v33, v24
  v_max3_f32 v28, v34, v35, v28
  s_nop 1
  v_max_f32_dpp v28, v28, v28 row_ror:8 row_mask:0xf bank_mask:0xf
  v_mov_b32 v29, v28
  s_nop 1
  v_permlane16_swap_b32 v28, v29
  v_max_f32 v28, v28, v29
  v_mov_b32 v29, v28
  s_nop 1
  v_permlane32_swap_b32 v28, v29
  v_max_f32 v28, v28, v29
  v_sub_f32 v29, v24, v28
  v_sub_f32 v32, v32, v28
  v_sub_f32 v33, v33, v28
  v_sub_f32 v34, v34, v28
  v_sub_f32 v35, v35, v28
  v_exp_f32 v29, v29
  v_exp_f32 v32, v32
  v_exp_f32 v33, v33
  v_exp_f32 v34, v34
  v_exp_f32 v35, v35
  v_mov_b32 v24, v28
  v_cvt_pk_bf16_f32 v36, v32, v33
  v_cvt_pk_bf16_f32 v37, v34, v35
  ds_write_b32 v10, v29
  ds_write_b64 v9, v[36:37] offset:16384
  ds_read_b64_tr_b16 a[48:49], v14 offset:128
  ds_read_b64_tr_b16 a[50:51], v14 offset:672
  ds_read_b64_tr_b16 a[52:53], v14 offset:4480
  ds_read_b64_tr_b16 a[54:55], v14 offset:5024
  ds_read_b64_tr_b16 a[56:57], v14 offset:192
  ds_read_b64_tr_b16 a[58:59], v14 offset:736
  ds_read_b64_tr_b16 a[60:61], v14 offset:4544
  ds_read_b64_tr_b16 a[62:63], v14 offset:5088
  v_pk_add_f32 v[32:33], v[32:33], v[34:35]
  v_fma_f32 v25, v25, v29, v32
  v_add_f32 v25, v25, v33
  s_waitcnt lgkmcnt(8)
  s_barrier
  ds_read_b32 v26, v11
  ds_read_b128 v[16:19], v12 offset:16384
  ds_read_b128 v[20:23], v12 offset:17408
  s_waitcnt vmcnt(8)
  ds_write_b128 v6, a[96:99] offset:0
  ds_write_b128 v6, a[100:103] offset:1088
  ds_write_b128 v6, a[104:107] offset:2176
  ds_write_b128 v6, a[108:111] offset:3264
  ds_write_b128 v6, a[112:115] offset:4352
  ds_write_b128 v6, a[116:119] offset:5440
  ds_write_b128 v6, a[120:123] offset:6528
  ds_write_b128 v6, a[124:127] offset:7616
  ds_read_b128 v[48:51], v7 offset:0
  ds_read_b128 v[52:55], v7 offset:32
  ds_read_b128 v[56:59], v7 offset:64
  ds_read_b128 v[60:63], v7 offset:96
  s_waitcnt lgkmcnt(14)
  v_pk_mul_f32 v[64:65], v[64:65], v[26:27] op_sel_hi:[1,0]
  v_pk_mul_f32 v[66:67], v[66:67], v[26:27] op_sel_hi:[1,0]
  v_pk_mul_f32 v[68:69], v[68:69], v[26:27] op_sel_hi:[1,0]
  v_pk_mul_f32 v[70:71], v[70:71], v[26:27] op_sel_hi:[1,0]
  v_pk_mul_f32 v[72:73], v[72:73], v[26:27] op_sel_hi:[1,0]
  v_pk_mul_f32 v[74:75], v[74:75], v[26:27] op_sel_hi:[1,0]
  v_pk_mul_f32 v[76:77], v[76:77], v[26:27] op_sel_hi:[1,0]
  v_pk_mul_f32 v[78:79], v[78:79], v[26:27] op_sel_hi:[1,0]
  s_waitcnt lgkmcnt(13)
  s_nop 0
  v_mfma_f32_32x32x16_bf16 v[64:79], a[32:35], v[16:19], v[64:79]
  s_waitcnt lgkmcnt(12)
  v_mfma_f32_32x32x16_bf16 v[64:79], a[36:39], v[20:23], v[64:79]
  v_pk_mul_f32 v[80:81], v[80:81], v[26:27] op_sel_hi:[1,0]
  v_pk_mul_f32 v[82:83], v[82:83], v[26:27] op_sel_hi:[1,0]
  v_pk_mul_f32 v[84:85], v[84:85], v[26:27] op_sel_hi:[1,0]
  v_pk_mul_f32 v[86:87], v[86:87], v[26:27] op_sel_hi:[1,0]
  v_pk_mul_f32 v[88:89], v[88:89], v[26:27] op_sel_hi:[1,0]
  v_pk_mul_f32 v[90:91], v[90:91], v[26:27] op_sel_hi:[1,0]
  v_pk_mul_f32 v[92:93], v[92:93], v[26:27] op_sel_hi:[1,0]
  v_pk_mul_f32 v[94:95], v[94:95], v[26:27] op_sel_hi:[1,0]
  s_nop 1
  v_mfma_f32_32x32x16_bf16 v[80:95], a[40:43], v[16:19], v[80:95]
  v_mfma_f32_32x32x16_bf16 v[80:95], a[44:47], v[20:23], v[80:95]
  v_pk_mul_f32 v[96:97], v[96:97], v[26:27] op_sel_hi:[1,0]
  v_pk_mul_f32 v[98:99], v[98:99], v[26:27] op_sel_hi:[1,0]
  v_pk_mul_f32 v[100:101], v[100:101], v[26:27] op_sel_hi:[1,0]
  v_pk_mul_f32 v[102:103], v[102:103], v[26:27] op_sel_hi:[1,0]
  v_pk_mul_f32 v[104:105], v[104:105], v[26:27] op_sel_hi:[1,0]
  v_pk_mul_f32 v[106:107], v[106:107], v[26:27] op_sel_hi:[1,0]
  v_pk_mul_f32 v[108:109], v[108:109], v[26:27] op_sel_hi:[1,0]
  v_pk_mul_f32 v[110:111], v[110:111], v[26:27] op_sel_hi:[1,0]
  s_nop 1
  v_mfma_f32_32x32x16_bf16 v[96:111], a[48:51], v[16:19], v[96:111]
  v_mfma_f32_32x32x16_bf16 v[96:111], a[52:55], v[20:23], v[96:111]
  ds_read_b128 a[32:35], v7 offset:128
  ds_read_b128 a[36:39], v7 offset:160
  ds_read_b128 a[40:43], v7 offset:192
  ds_read_b128 a[44:47], v7 offset:224
  v_pk_mul_f32 v[112:113], v[112:113], v[26:27] op_sel_hi:[1,0]
  v_pk_mul_f32 v[114:115], v[114:115], v[26:27] op_sel_hi:[1,0]
  v_pk_mul_f32 v[116:117], v[116:117], v[26:27] op_sel_hi:[1,0]
  v_pk_mul_f32 v[118:119], v[118:119], v[26:27] op_sel_hi:[1,0]
  v_pk_mul_f32 v[120:121], v[120:121], v[26:27] op_sel_hi:[1,0]
  v_pk_mul_f32 v[122:123], v[122:123], v[26:27] op_sel_hi:[1,0]
  v_pk_mul_f32 v[124:125], v[124:125], v[26:27] op_sel_hi:[1,0]
  v_pk_mul_f32 v[126:127], v[126:127], v[26:27] op_sel_hi:[1,0]
  s_nop 1
  v_mfma_f32_32x32x16_bf16 v[112:127], a[56:59], v[16:19], v[112:127]
  v_mfma_f32_32x32x16_bf16 v[112:127], a[60:63], v[20:23], v[112:127]
  s_waitcnt lgkmcnt(4)
  buffer_load_dwordx4 a[96:99], v5, s[32:35], s48 offen nt
  s_add_u32 s48, s48, s50
  buffer_load_dwordx4 a[100:103], v5, s[32:35], s48 offen nt
  s_add_u32 s48, s48, s50
  buffer_load_dwordx4 a[104:107], v5, s[32:35], s48 offen nt
  s_add_u32 s48, s48, s50
  buffer_load_dwordx4 a[108:111], v5, s[32:35], s48 offen nt
  s_add_u32 s48, s48, s50
  v_mfma_f32_32x32x16_bf16 v[32:47], v[48:51], a[0:3], 0
  v_mfma_f32_32x32x16_bf16 v[32:47], v[52:55], a[4:7], v[32:47]
  v_mfma_f32_32x32x16_bf16 v[32:47], v[56:59], a[8:11], v[32:47]
  v_mfma_f32_32x32x16_bf16 v[32:47], v[60:63], a[12:15], v[32:47]
  s_waitcnt lgkmcnt(3)
  v_mfma_f32_32x32x16_bf16 v[32:47], a[32:35], a[16:19], v[32:47]
  s_waitcnt lgkmcnt(2)
  v_mfma_f32_32x32x16_bf16 v[32:47], a[36:39], a[20:23], v[32:47]
  s_waitcnt lgkmcnt(1)
  v_mfma_f32_32x32x16_bf16 v[32:47], a[40:43], a[24:27], v[32:47]
  s_waitcnt lgkmcnt(0)
  v_mfma_f32_32x32x16_bf16 v[32:47], a[44:47], a[28:31], v[32:47]
  buffer_load_dwordx4 a[112:115], v5, s[32:35], s48 offen nt
  s_add_u32 s48, s48, s50
  buffer_load_dwordx4 a[116:119], v5, s[32:35], s48 offen nt
  s_add_u32 s48, s48, s50
  buffer_load_dwordx4 a[120:123], v5, s[32:35], s48 offen nt
  s_add_u32 s48, s48, s50
  buffer_load_dwordx4 a[124:127], v5, s[32:35], s48 offen nt
  s_add_u32 s48, s48, s50
  s_nop 3
  ds_write_b128 v13, v[32:35] offset:0
  ds_write_b128 v13, v[36:39] offset:1024
  ds_write_b128 v13, v[40:43] offset:2048
  ds_write_b128 v13, v[44:47] offset:3072
  s_waitcnt lgkmcnt(0)
  s_barrier
  ds_read_b128 v[32:35], v8 offset:0
  ds_read_b128 v[36:39], v8 offset:4096
  ds_read_b128 v[40:43], v8 offset:8192
  ds_read_b128 v[44:47], v8 offset:12288
  ds_read_b64_tr_b16 a[32:33], v14 offset:0
  ds_read_b64_tr_b16 a[34:35], v14 offset:544
  ds_read_b64_tr_b16 a[36:37], v14 offset:4352
  ds_read_b64_tr_b16 a[38:39], v14 offset:4896
  ds_read_b64_tr_b16 a[40:41], v14 offset:64
  ds_read_b64_tr_b16 a[42:43], v14 offset:608
  ds_read_b64_tr_b16 a[44:45], v14 offset:4416
  ds_read_b64_tr_b16 a[46:47], v14 offset:4960
  s_waitcnt lgkmcnt(10)
  v_pk_add_f32 v[32:33], v[32:33], v[36:37]
  v_pk_add_f32 v[34:35], v[34:35], v[38:39]
  s_waitcnt lgkmcnt(8)
  v_pk_add_f32 v[40:41], v[40:41], v[44:45]
  v_pk_add_f32 v[42:43], v[42:43], v[46:47]
  v_pk_add_f32 v[32:33], v[32:33], v[40:41]
  v_pk_add_f32 v[34:35], v[34:35], v[42:43]
  v_cvt_pk_bf16_f32 v36, v32, v33
  v_cvt_pk_bf16_f32 v37, v34, v35
  v_lshlrev_b32 v32, 16, v36
  v_and_b32 v33, 0xffff0000, v36
  v_lshlrev_b32 v34, 16, v37
  v_and_b32 v35, 0xffff0000, v37
  v_mul_f32 v32, 0x3db504f3, v32
  v_mul_f32 v33, 0x3db504f3, v33
  v_mul_f32 v34, 0x3db504f3, v34
  v_mul_f32 v35, 0x3db504f3, v35
  v_cvt_pk_bf16_f32 v36, v32, v33
  v_cvt_pk_bf16_f32 v37, v34, v35
  v_lshlrev_b32 v32, 16, v36
  v_and_b32 v33, 0xffff0000, v36
  v_lshlrev_b32 v34, 16, v37
  v_and_b32 v35, 0xffff0000, v37
  v_mul_f32 v32, 0x3fb8aa3b, v32
  v_mul_f32 v33, 0x3fb8aa3b, v33
  v_mul_f32 v34, 0x3fb8aa3b, v34
  v_mul_f32 v35, 0x3fb8aa3b, v35
  v_max3_f32 v28, v32, v33, v24
  v_max3_f32 v28, v34, v35, v28
  s_nop 1
  v_max_f32_dpp v28, v28, v28 row_ror:8 row_mask:0xf bank_mask:0xf
  v_mov_b32 v29, v28
  s_nop 1
  v_permlane16_swap_b32 v28, v29
  v_max_f32 v28, v28, v29
  v_mov_b32 v29, v28
  s_nop 1
  v_permlane32_swap_b32 v28, v29
  v_max_f32 v28, v28, v29
  v_sub_f32 v29, v24, v28
  v_sub_f32 v32, v32, v28
  v_sub_f32 v33, v33, v28
  v_sub_f32 v34, v34, v28
  v_sub_f32 v35, v35, v28
  v_exp_f32 v29, v29
  v_exp_f32 v32, v32
  v_exp_f32 v33, v33
  v_exp_f32 v34, v34
  v_exp_f32 v35, v35
  v_mov_b32 v24, v28
  v_cvt_pk_bf16_f32 v36, v32, v33
  v_cvt_pk_bf16_f32 v37, v34, v35
  ds_write_b32 v10, v29
  ds_write_b64 v9, v[36:37] offset:16384
  ds_read_b64_tr_b16 a[48:49], v14 offset:128
  ds_read_b64_tr_b16 a[50:51], v14 offset:672
  ds_read_b64_tr_b16 a[52:53], v14 offset:4480
  ds_read_b64_tr_b16 a[54:55], v14 offset:5024
  ds_read_b64_tr_b16 a[56:57], v14 offset:192
  ds_read_b64_tr_b16 a[58:59], v14 offset:736
  ds_read_b64_tr_b16 a[60:61], v14 offset:4544
  ds_read_b64_tr_b16 a[62:63], v14 offset:5088
  v_pk_add_f32 v[32:33], v[32:33], v[34:35]
  v_fma_f32 v25, v25, v29, v32
  v_add_f32 v25, v25, v33
  s_waitcnt lgkmcnt(8)
  s_barrier
  ds_read_b32 v26, v11
  ds_read_b128 v[16:19], v12 offset:16384
  ds_read_b128 v[20:23], v12 offset:17408
  s_waitcnt lgkmcnt(2)
  v_pk_mul_f32 v[64:65], v[64:65], v[26:27] op_sel_hi:[1,0]
  v_pk_mul_f32 v[66:67], v[66:67], v[26:27] op_sel_hi:[1,0]
  v_pk_mul_f32 v[68:69], v[68:69], v[26:27] op_sel_hi:[1,0]
  v_pk_mul_f32 v[70:71], v[70:71], v[26:27] op_sel_hi:[1,0]
  v_pk_mul_f32 v[72:73], v[72:73], v[26:27] op_sel_hi:[1,0]
  v_pk_mul_f32 v[74:75], v[74:75], v[26:27] op_sel_hi:[1,0]
  v_pk_mul_f32 v[76:77], v[76:77], v[26:27] op_sel_hi:[1,0]
  v_pk_mul_f32 v[78:79], v[78:79], v[26:27] op_sel_hi:[1,0]
  s_waitcnt lgkmcnt(1)
  s_nop 0
  v_mfma_f32_32x32x16_bf16 v[64:79], a[32:35], v[16:19], v[64:79]
  s_waitcnt lgkmcnt(0)
  v_mfma_f32_32x32x16_bf16 v[64:79], a[36:39], v[20:23], v[64:79]
  v_pk_mul_f32 v[80:81], v[80:81], v[26:27] op_sel_hi:[1,0]
  v_pk_mul_f32 v[82:83], v[82:83], v[26:27] op_sel_hi:[1,0]
  v_pk_mul_f32 v[84:85], v[84:85], v[26:27] op_sel_hi:[1,0]
  v_pk_mul_f32 v[86:87], v[86:87], v[26:27] op_sel_hi:[1,0]
  v_pk_mul_f32 v[88:89], v[88:89], v[26:27] op_sel_hi:[1,0]
  v_pk_mul_f32 v[90:91], v[90:91], v[26:27] op_sel_hi:[1,0]
  v_pk_mul_f32 v[92:93], v[92:93], v[26:27] op_sel_hi:[1,0]
  v_pk_mul_f32 v[94:95], v[94:95], v[26:27] op_sel_hi:[1,0]
  s_nop 1
  v_mfma_f32_32x32x16_bf16 v[80:95], a[40:43], v[16:19], v[80:95]
  v_mfma_f32_32x32x16_bf16 v[80:95], a[44:47], v[20:23], v[80:95]
  v_pk_mul_f32 v[96:97], v[96:97], v[26:27] op_sel_hi:[1,0]
  v_pk_mul_f32 v[98:99], v[98:99], v[26:27] op_sel_hi:[1,0]
  v_pk_mul_f32 v[100:101], v[100:101], v[26:27] op_sel_hi:[1,0]
  v_pk_mul_f32 v[102:103], v[102:103], v[26:27] op_sel_hi:[1,0]
  v_pk_mul_f32 v[104:105], v[104:105], v[26:27] op_sel_hi:[1,0]
  v_pk_mul_f32 v[106:107], v[106:107], v[26:27] op_sel_hi:[1,0]
  v_pk_mul_f32 v[108:109], v[108:109], v[26:27] op_sel_hi:[1,0]
  v_pk_mul_f32 v[110:111], v[110:111], v[26:27] op_sel_hi:[1,0]
  s_nop 1
  v_mfma_f32_32x32x16_bf16 v[96:111], a[48:51], v[16:19], v[96:111]
  v_mfma_f32_32x32x16_bf16 v[96:111], a[52:55], v[20:23], v[96:111]
  v_pk_mul_f32 v[112:113], v[112:113], v[26:27] op_sel_hi:[1,0]
  v_pk_mul_f32 v[114:115], v[114:115], v[26:27] op_sel_hi:[1,0]
  v_pk_mul_f32 v[116:117], v[116:117], v[26:27] op_sel_hi:[1,0]
  v_pk_mul_f32 v[118:119], v[118:119], v[26:27] op_sel_hi:[1,0]
  v_pk_mul_f32 v[120:121], v[120:121], v[26:27] op_sel_hi:[1,0]
  v_pk_mul_f32 v[122:123], v[122:123], v[26:27] op_sel_hi:[1,0]
  v_pk_mul_f32 v[124:125], v[124:125], v[26:27] op_sel_hi:[1,0]
  v_pk_mul_f32 v[126:127], v[126:127], v[26:27] op_sel_hi:[1,0]
  s_nop 1
  v_mfma_f32_32x32x16_bf16 v[112:127], a[56:59], v[16:19], v[112:127]
  v_mfma_f32_32x32x16_bf16 v[112:127], a[60:63], v[20:23], v[112:127]
  s_lshl_b32 s41, s37, 17
  s_lshl_b32 s3, s38, 16
  s_add_u32 s41, s41, s3
  s_add_u32 s24, s16, s41
  s_addc_u32 s25, s17, 0
  s_mov_b32 s26, 65536
  s_mov_b32 s27, 0x00020000
  s_lshl_b32 s3, s49, 8
  v_lshl_add_u32 v31, v2, 4, s3
  v_lshl_add_u32 v31, v3, 14, v31
  s_cmp_lg_u32 s36, 0
  s_nop 0
  s_cbranch_scc1 L_B_wo0
  s_mov_b32 s42, 0
  buffer_load_dwordx4 a[0:3], v31, s[24:27], s42 offen offset:0 nt
  buffer_load_dwordx4 a[4:7], v31, s[24:27], s42 offen offset:1024 nt
  buffer_load_dwordx4 a[8:11], v31, s[24:27], s42 offen offset:2048 nt
  buffer_load_dwordx4 a[12:15], v31, s[24:27], s42 offen offset:3072 nt
  s_add_u32 s42, s42, 0x1000
  buffer_load_dwordx4 a[16:19], v31, s[24:27], s42 offen offset:0 nt
  buffer_load_dwordx4 a[20:23], v31, s[24:27], s42 offen offset:1024 nt
  buffer_load_dwordx4 a[24:27], v31, s[24:27], s42 offen offset:2048 nt
  buffer_load_dwordx4 a[28:31], v31, s[24:27], s42 offen offset:3072 nt
  s_add_u32 s42, s42, 0x1000
  buffer_load_dwordx4 a[32:35], v31, s[24:27], s42 offen offset:0 nt
  buffer_load_dwordx4 a[36:39], v31, s[24:27], s42 offen offset:1024 nt
  buffer_load_dwordx4 a[40:43], v31, s[24:27], s42 offen offset:2048 nt
  buffer_load_dwordx4 a[44:47], v31, s[24:27], s42 offen offset:3072 nt
  s_add_u32 s42, s42, 0x1000
  buffer_load_dwordx4 a[48:51], v31, s[24:27], s42 offen offset:0 nt
  buffer_load_dwordx4 a[52:55], v31, s[24:27], s42 offen offset:1024 nt
  buffer_load_dwordx4 a[56:59], v31, s[24:27], s42 offen offset:2048 nt
  buffer_load_dwordx4 a[60:63], v31, s[24:27], s42 offen offset:3072 nt
L_B_wo0:
  v_add_f32_dpp v25, v25, v25 row_ror:8 row_mask:0xf bank_mask:0xf
  v_mov_b32 v29, v25
  s_nop 1
  v_permlane16_swap_b32 v25, v29
  v_add_f32 v25, v25, v29
  v_mov_b32 v29, v25
  s_nop 1
  v_permlane32_swap_b32 v25, v29
  v_add_f32 v25, v25, v29
  v_lshrrev_b32 v29, 5, v1
  v_and_b32 v30, 31, v1
  v_mul_u32_u24 v30, 272, v30
  v_lshl_add_u32 v30, v29, 3, v30
  s_mul_i32 s3, s36, 8704
  v_add_u32 v30, s3, v30
  v_cvt_pk_bf16_f32 v32, v64, v65
  v_cvt_pk_bf16_f32 v33, v66, v67
  ds_write_b64 v30, v[32:33] offset:0
  v_cvt_pk_bf16_f32 v34, v68, v69
  v_cvt_pk_bf16_f32 v35, v70, v71
  ds_write_b64 v30, v[34:35] offset:16
  v_cvt_pk_bf16_f32 v36, v72, v73
  v_cvt_pk_bf16_f32 v37, v74, v75
  ds_write_b64 v30, v[36:37] offset:32
  v_cvt_pk_bf16_f32 v38, v76, v77
  v_cvt_pk_bf16_f32 v39, v78, v79
  ds_write_b64 v30, v[38:39] offset:48
  v_cvt_pk_bf16_f32 v40, v80, v81
  v_cvt_pk_bf16_f32 v41, v82, v83
  ds_write_b64 v30, v[40:41] offset:64
  v_cvt_pk_bf16_f32 v42, v84, v85
  v_cvt_pk_bf16_f32 v43, v86, v87
  ds_write_b64 v30, v[42:43] offset:80
  v_cvt_pk_bf16_f32 v44, v88, v89
  v_cvt_pk_bf16_f32 v45, v90, v91
  ds_write_b64 v30, v[44:45] offset:96
  v_cvt_pk_bf16_f32 v46, v92, v93
  v_cvt_pk_bf16_f32 v47, v94, v95
  ds_write_b64 v30, v[46:47] offset:112
  v_cvt_pk_bf16_f32 v32, v96, v97
  v_cvt_pk_bf16_f32 v33, v98, v99
  ds_write_b64 v30, v[32:33] offset:128
  v_cvt_pk_bf16_f32 v34, v100, v101
  v_cvt_pk_bf16_f32 v35, v102, v103
  ds_write_b64 v30, v[34:35] offset:144
  v_cvt_pk_bf16_f32 v36, v104, v105
  v_cvt_pk_bf16_f32 v37, v106, v107
  ds_write_b64 v30, v[36:37] offset:160
  v_cvt_pk_bf16_f32 v38, v108, v109
  v_cvt_pk_bf16_f32 v39, v110, v111
  ds_write_b64 v30, v[38:39] offset:176
  v_cvt_pk_bf16_f32 v40, v112, v113
  v_cvt_pk_bf16_f32 v41, v114, v115
  ds_write_b64 v30, v[40:41] offset:192
  v_cvt_pk_bf16_f32 v42, v116, v117
  v_cvt_pk_bf16_f32 v43, v118, v119
  ds_write_b64 v30, v[42:43] offset:208
  v_cvt_pk_bf16_f32 v44, v120, v121
  v_cvt_pk_bf16_f32 v45, v122, v123
  ds_write_b64 v30, v[44:45] offset:224
  v_cvt_pk_bf16_f32 v46, v124, v125
  v_cvt_pk_bf16_f32 v47, v126, v127
  ds_write_b64 v30, v[46:47] offset:240
  ds_read_b128 v[64:67], v6 offset:0
  ds_read_b128 v[68:71], v6 offset:1088
  ds_read_b128 v[72:75], v6 offset:2176
  ds_read_b128 v[76:79], v6 offset:3264
  ds_read_b128 v[80:83], v6 offset:4352
  ds_read_b128 v[84:87], v6 offset:5440
  ds_read_b128 v[88:91], v6 offset:6528
  ds_read_b128 v[92:95], v6 offset:7616
  s_lshl_b32 s40, s39, 15
  s_add_u32 s40, s40, 1048576
  s_add_u32 s32, s56, s40
  s_addc_u32 s33, s57, 0
  s_mov_b32 s34, 32768
  s_mov_b32 s35, 0x00020000
  v_and_b32 v28, 7, v1
  s_lshl_b32 s3, s39, 2
  s_add_u32 s3, s3, s49
  s_lshl_b32 s3, s3, 6
  s_add_u32 s3, s3, 65536
  v_lshl_add_u32 v28, v28, 3, s3
  global_store_dwordx2 v28, v[24:25], s[56:57] sc1
  s_mov_b32 s42, 0
  s_waitcnt lgkmcnt(7)
  buffer_store_dwordx4 v[64:67], v27, s[32:35], s42 offen sc1
  s_add_u32 s42, s42, 0x1000
  s_waitcnt lgkmcnt(6)
  buffer_store_dwordx4 v[68:71], v27, s[32:35], s42 offen sc1
  s_add_u32 s42, s42, 0x1000
  s_waitcnt lgkmcnt(5)
  buffer_store_dwordx4 v[72:75], v27, s[32:35], s42 offen sc1
  s_add_u32 s42, s42, 0x1000
  s_waitcnt lgkmcnt(4)
  buffer_store_dwordx4 v[76:79], v27, s[32:35], s42 offen sc1
  s_add_u32 s42, s42, 0x1000
  s_waitcnt lgkmcnt(3)
  buffer_store_dwordx4 v[80:83], v27, s[32:35], s42 offen sc1
  s_add_u32 s42, s42, 0x1000
  s_waitcnt lgkmcnt(2)
  buffer_store_dwordx4 v[84:87], v27, s[32:35], s42 offen sc1
  s_add_u32 s42, s42, 0x1000
  s_waitcnt lgkmcnt(1)
  buffer_store_dwordx4 v[88:91], v27, s[32:35], s42 offen sc1
  s_add_u32 s42, s42, 0x1000
  s_waitcnt lgkmcnt(0)
  buffer_store_dwordx4 v[92:95], v27, s[32:35], s42 offen sc1
  s_waitcnt vmcnt(0)
  s_barrier
  s_cmp_lg_u32 s36, 0
  s_cbranch_scc1 L_B_sig2_skip
  s_mov_b64 exec, 1
  v_mov_b32 v29, 1
  global_atomic_add v4, v29, s[54:55] offset:64 sc1
  s_mov_b64 exec, -1
L_B_sig2_skip:
  s_cmp_eq_u32 s36, 0
  s_cbranch_scc1 L_B_wo1
  s_mov_b32 s42, 0
  buffer_load_dwordx4 a[0:3], v31, s[24:27], s42 offen offset:0 nt
  buffer_load_dwordx4 a[4:7], v31, s[24:27], s42 offen offset:1024 nt
  buffer_load_dwordx4 a[8:11], v31, s[24:27], s42 offen offset:2048 nt
  buffer_load_dwordx4 a[12:15], v31, s[24:27], s42 offen offset:3072 nt
  s_add_u32 s42, s42, 0x1000
  buffer_load_dwordx4 a[16:19], v31, s[24:27], s42 offen offset:0 nt
  buffer_load_dwordx4 a[20:23], v31, s[24:27], s42 offen offset:1024 nt
  buffer_load_dwordx4 a[24:27], v31, s[24:27], s42 offen offset:2048 nt
  buffer_load_dwordx4 a[28:31], v31, s[24:27], s42 offen offset:3072 nt
  s_add_u32 s42, s42, 0x1000
  buffer_load_dwordx4 a[32:35], v31, s[24:27], s42 offen offset:0 nt
  buffer_load_dwordx4 a[36:39], v31, s[24:27], s42 offen offset:1024 nt
  buffer_load_dwordx4 a[40:43], v31, s[24:27], s42 offen offset:2048 nt
  buffer_load_dwordx4 a[44:47], v31, s[24:27], s42 offen offset:3072 nt
  s_add_u32 s42, s42, 0x1000
  buffer_load_dwordx4 a[48:51], v31, s[24:27], s42 offen offset:0 nt
  buffer_load_dwordx4 a[52:55], v31, s[24:27], s42 offen offset:1024 nt
  buffer_load_dwordx4 a[56:59], v31, s[24:27], s42 offen offset:2048 nt
  buffer_load_dwordx4 a[60:63], v31, s[24:27], s42 offen offset:3072 nt
L_B_wo1:
  s_lshl_b32 s40, s36, 18
  s_lshl_b32 s3, s37, 10
  s_add_u32 s40, s40, s3
  s_add_u32 s40, s40, 1048576
  s_add_u32 s32, s56, s40
  s_addc_u32 s33, s57, 0
  s_mov_b32 s34, 262144
  s_mov_b32 s35, 0x00020000
  v_lshlrev_b32 v5, 4, v1
  v_and_b32 v30, 31, v1
  s_lshl_b32 s3, s38, 13
  s_lshl_b32 s40, s37, 3
  s_add_u32 s40, s40, 65536
  s_add_u32 s3, s3, s40
  v_lshl_add_u32 v6, v30, 8, s3
  s_lshl_b32 s3, s36, 11
  s_add_u32 s3, s3, 69632
  v_lshl_add_u32 v14, v1, 5, s3
  v_mov_b32 v28, 0x0100
  v_mov_b32 v29, 0x0302
  v_cmp_gt_u32 vcc, 8, v2
  s_nop 1
  v_cndmask_b32 v28, v29, v28, vcc
  v_lshlrev_b32 v29, 16, v28
  v_or_b32 v29, 0x0c0c, v29
  v_or_b32 v28, 0x0c0c0000, v28
  v_and_b32 v30, 1, v2
  v_cmp_eq_u32 vcc, 1, v30
  s_nop 1
  v_cndmask_b32 v28, v28, v29, vcc
  v_bfe_u32 v29, v2, 1, 2
  v_mov_b32 v30, 0x0c0c0c0c
  v_cmp_eq_u32 vcc, 0, v29
  s_nop 1
  v_cndmask_b32 v8, v30, v28, vcc
  v_cmp_eq_u32 vcc, 1, v29
  s_nop 1
  v_cndmask_b32 v9, v30, v28, vcc
  v_cmp_eq_u32 vcc, 2, v29
  s_nop 1
  v_cndmask_b32 v10, v30, v28, vcc
  v_cmp_eq_u32 vcc, 3, v29
  s_nop 1
  v_cndmask_b32 v11, v30, v28, vcc
  s_cmp_lg_u32 s36, 0
  s_nop 0
  s_cbranch_scc1 L_B_p2_done
  s_mov_b32 s40, 0
L_B_p2_loop:
  global_load_dwordx2 v[28:29], v4, s[54:55] offset:64 sc1
  s_waitcnt vmcnt(0)
  v_cmp_le_u32 vcc, 224, v29
  s_nop 1
  v_cndmask_b32 v28, 0, v28, vcc
  s_nop 0
  v_readfirstlane_b32 s3, v28
  s_cmp_ge_u32 s3, 32
  s_nop 3
  s_cbranch_scc1 L_B_p2_done
  s_sleep 2
  s_add_u32 s40, s40, 1
  s_cmp_lt_u32 s40, 0x8000
  s_cbranch_scc1 L_B_p2_loop
L_B_p2_done:
  s_barrier
  global_load_dwordx2 v[12:13], v6, s[56:57] sc1
  s_mov_b32 s42, 0
  buffer_load_dwordx4 v[64:67], v5, s[32:35], s42 offen sc1
  s_add_u32 s42, s42, 0x8000
  buffer_load_dwordx4 v[68:71], v5, s[32:35], s42 offen sc1
  s_add_u32 s42, s42, 0x8000
  buffer_load_dwordx4 v[72:75], v5, s[32:35], s42 offen sc1
  s_add_u32 s42, s42, 0x8000
  buffer_load_dwordx4 v[76:79], v5, s[32:35], s42 offen sc1
  s_add_u32 s42, s42, 0x8000
  buffer_load_dwordx4 v[80:83], v5, s[32:35], s42 offen sc1
  s_add_u32 s42, s42, 0x8000
  buffer_load_dwordx4 v[84:87], v5, s[32:35], s42 offen sc1
  s_add_u32 s42, s42, 0x8000
  buffer_load_dwordx4 v[88:91], v5, s[32:35], s42 offen sc1
  s_add_u32 s42, s42, 0x8000
  buffer_load_dwordx4 v[92:95], v5, s[32:35], s42 offen sc1
  s_waitcnt vmcnt(8)
  v_mov_b32 v6, v12
  s_nop 1
  v_max_f32_dpp v6, v6, v6 row_ror:8 row_mask:0xf bank_mask:0xf
  s_nop 1
  v_max_f32_dpp v6, v6, v6 row_ror:4 row_mask:0xf bank_mask:0xf
  s_nop 1
  v_max_f32_dpp v6, v6, v6 row_ror:2 row_mask:0xf bank_mask:0xf
  s_nop 1
  v_max_f32_dpp v6, v6, v6 row_ror:1 row_mask:0xf bank_mask:0xf
  v_mov_b32 v7, v6
  s_nop 1
  v_permlane16_swap_b32 v6, v7
  v_max_f32 v6, v6, v7
  v_sub_f32 v12, v12, v6
  v_exp_f32 v12, v12
  s_nop 0
  v_mul_f32 v6, v12, v13
  s_nop 1
  v_add_f32_dpp v6, v6, v6 row_ror:8 row_mask:0xf bank_mask:0xf
  s_nop 1
  v_add_f32_dpp v6, v6, v6 row_ror:4 row_mask:0xf bank_mask:0xf
  s_nop 1
  v_add_f32_dpp v6, v6, v6 row_ror:2 row_mask:0xf bank_mask:0xf
  s_nop 1
  v_add_f32_dpp v6, v6, v6 row_ror:1 row_mask:0xf bank_mask:0xf
  v_mov_b32 v7, v6
  s_nop 1
  v_permlane16_swap_b32 v6, v7
  v_add_f32 v6, v6, v7
  v_rcp_f32 v6, v6
  s_nop 0
  v_mul_f32 v12, v12, v6
  s_lshl_b32 s3, s49, 3
  v_readlane_b32 s84, v12, s3
  s_add_u32 s3, s3, 1
  v_readlane_b32 s85, v12, s3
  s_add_u32 s3, s3, 1
  v_readlane_b32 s86, v12, s3
  s_add_u32 s3, s3, 1
  v_readlane_b32 s87, v12, s3
  s_add_u32 s3, s3, 1
  v_readlane_b32 s88, v12, s3
  s_add_u32 s3, s3, 1
  v_readlane_b32 s89, v12, s3
  s_add_u32 s3, s3, 1
  v_readlane_b32 s90, v12, s3
  s_add_u32 s3, s3, 1
  v_readlane_b32 s91, v12, s3
  s_waitcnt vmcnt(7)
  v_lshlrev_b32 v6, 16, v64
  v_and_b32 v7, 0xffff0000, v64
  v_mul_f32 v32, s84, v6
  v_mul_f32 v33, s84, v7
  v_lshlrev_b32 v6, 16, v65
  v_and_b32 v7, 0xffff0000, v65
  v_mul_f32 v34, s84, v6
  v_mul_f32 v35, s84, v7
  v_lshlrev_b32 v6, 16, v66
  v_and_b32 v7, 0xffff0000, v66
  v_mul_f32 v36, s84, v6
  v_mul_f32 v37, s84, v7
  v_lshlrev_b32 v6, 16, v67
  v_and_b32 v7, 0xffff0000, v67
  v_mul_f32 v38, s84, v6
  v_mul_f32 v39, s84, v7
  s_waitcnt vmcnt(6)
  v_lshlrev_b32 v6, 16, v68
  v_and_b32 v7, 0xffff0000, v68
  v_fmac_f32 v32, s85, v6
  v_fmac_f32 v33, s85, v7
  v_lshlrev_b32 v6, 16, v69
  v_and_b32 v7, 0xffff0000, v69
  v_fmac_f32 v34, s85, v6
  v_fmac_f32 v35, s85, v7
  v_lshlrev_b32 v6, 16, v70
  v_and_b32 v7, 0xffff0000, v70
  v_fmac_f32 v36, s85, v6
  v_fmac_f32 v37, s85, v7
  v_lshlrev_b32 v6, 16, v71
  v_and_b32 v7, 0xffff0000, v71
  v_fmac_f32 v38, s85, v6
  v_fmac_f32 v39, s85, v7
  s_waitcnt vmcnt(5)
  v_lshlrev_b32 v6, 16, v72
  v_and_b32 v7, 0xffff0000, v72
  v_fmac_f32 v32, s86, v6
  v_fmac_f32 v33, s86, v7
  v_lshlrev_b32 v6, 16, v73
  v_and_b32 v7, 0xffff0000, v73
  v_fmac_f32 v34, s86, v6
  v_fmac_f32 v35, s86, v7
  v_lshlrev_b32 v6, 16, v74
  v_and_b32 v7, 0xffff0000, v74
  v_fmac_f32 v36, s86, v6
  v_fmac_f32 v37, s86, v7
  v_lshlrev_b32 v6, 16, v75
  v_and_b32 v7, 0xffff0000, v75
  v_fmac_f32 v38, s86, v6
  v_fmac_f32 v39, s86, v7
  s_waitcnt vmcnt(4)
  v_lshlrev_b32 v6, 16, v76
  v_and_b32 v7, 0xffff0000, v76
  v_fmac_f32 v32, s87, v6
  v_fmac_f32 v33, s87, v7
  v_lshlrev_b32 v6, 16, v77
  v_and_b32 v7, 0xffff0000, v77
  v_fmac_f32 v34, s87, v6
  v_fmac_f32 v35, s87, v7
  v_lshlrev_b32 v6, 16, v78
  v_and_b32 v7, 0xffff0000, v78
  v_fmac_f32 v36, s87, v6
  v_fmac_f32 v37, s87, v7
  v_lshlrev_b32 v6, 16, v79
  v_and_b32 v7, 0xffff0000, v79
  v_fmac_f32 v38, s87, v6
  v_fmac_f32 v39, s87, v7
  s_waitcnt vmcnt(3)
  v_lshlrev_b32 v6, 16, v80
  v_and_b32 v7, 0xffff0000, v80
  v_fmac_f32 v32, s88, v6
  v_fmac_f32 v33, s88, v7
  v_lshlrev_b32 v6, 16, v81
  v_and_b32 v7, 0xffff0000, v81
  v_fmac_f32 v34, s88, v6
  v_fmac_f32 v35, s88, v7
  v_lshlrev_b32 v6, 16, v82
  v_and_b32 v7, 0xffff0000, v82
  v_fmac_f32 v36, s88, v6
  v_fmac_f32 v37, s88, v7
  v_lshlrev_b32 v6, 16, v83
  v_and_b32 v7, 0xffff0000, v83
  v_fmac_f32 v38, s88, v6
  v_fmac_f32 v39, s88, v7
  s_waitcnt vmcnt(2)
  v_lshlrev_b32 v6, 16, v84
  v_and_b32 v7, 0xffff0000, v84
  v_fmac_f32 v32, s89, v6
  v_fmac_f32 v33, s89, v7
  v_lshlrev_b32 v6, 16, v85
  v_and_b32 v7, 0xffff0000, v85
  v_fmac_f32 v34, s89, v6
  v_fmac_f32 v35, s89, v7
  v_lshlrev_b32 v6, 16, v86
  v_and_b32 v7, 0xffff0000, v86
  v_fmac_f32 v36, s89, v6
  v_fmac_f32 v37, s89, v7
  v_lshlrev_b32 v6, 16, v87
  v_and_b32 v7, 0xffff0000, v87
  v_fmac_f32 v38, s89, v6
  v_fmac_f32 v39, s89, v7
  s_waitcnt vmcnt(1)
  v_lshlrev_b32 v6, 16, v88
  v_and_b32 v7, 0xffff0000, v88
  v_fmac_f32 v32, s90, v6
  v_fmac_f32 v33, s90, v7
  v_lshlrev_b32 v6, 16, v89
  v_and_b32 v7, 0xffff0000, v89
  v_fmac_f32 v34, s90, v6
  v_fmac_f32 v35, s90, v7
  v_lshlrev_b32 v6, 16, v90
  v_and_b32 v7, 0xffff0000, v90
  v_fmac_f32 v36, s90, v6
  v_fmac_f32 v37, s90, v7
  v_lshlrev_b32 v6, 16, v91
  v_and_b32 v7, 0xffff0000, v91
  v_fmac_f32 v38, s90, v6
  v_fmac_f32 v39, s90, v7
  s_waitcnt vmcnt(0)
  v_lshlrev_b32 v6, 16, v92
  v_and_b32 v7, 0xffff0000, v92
  v_fmac_f32 v32, s91, v6
  v_fmac_f32 v33, s91, v7
  v_lshlrev_b32 v6, 16, v93
  v_and_b32 v7, 0xffff0000, v93
  v_fmac_f32 v34, s91, v6
  v_fmac_f32 v35, s91, v7
  v_lshlrev_b32 v6, 16, v94
  v_and_b32 v7, 0xffff0000, v94
  v_fmac_f32 v36, s91, v6
  v_fmac_f32 v37, s91, v7
  v_lshlrev_b32 v6, 16, v95
  v_and_b32 v7, 0xffff0000, v95
  v_fmac_f32 v38, s91, v6
  v_fmac_f32 v39, s91, v7
  ds_write_b128 v14, v[32:35]
  ds_write_b128 v14, v[36:39] offset:16
  v_lshl_add_u32 v28, v3, 4, v2
  s_lshl_b32 s3, s36, 8
  s_add_u32 s3, s3, 69632
  v_lshl_add_u32 v28, v28, 2, s3
  s_waitcnt lgkmcnt(0)
  s_barrier
  ds_read2st64_b32 v[40:41], v28 offset0:0 offset1:8
  ds_read2st64_b32 v[42:43], v28 offset0:16 offset1:24
  ds_read2st64_b32 v[44:45], v28 offset0:32 offset1:40
  ds_read2st64_b32 v[46:47], v28 offset0:48 offset1:56
  s_waitcnt lgkmcnt(0)
  v_pk_add_f32 v[40:41], v[40:41], v[42:43]
  v_add_f32 v40, v40, v41
  v_pk_add_f32 v[44:45], v[44:45], v[46:47]
  v_add_f32 v44, v44, v45
  v_cvt_pk_bf16_f32 v12, v40, v44
  s_nop 1
  v_mov_b32_dpp v28, v12 row_newbcast:0 row_mask:0xf bank_mask:0xf
  v_perm_b32 v16, v28, v28, v8
  v_perm_b32 v17, v28, v28, v9
  v_perm_b32 v18, v28, v28, v10
  v_perm_b32 v19, v28, v28, v11
  s_nop 1
  v_mfma_f32_16x16x32_bf16 v[24:27], v[16:19], a[64:67], 0
  v_mov_b32_dpp v29, v12 row_newbcast:1 row_mask:0xf bank_mask:0xf
  v_perm_b32 v20, v29, v29, v8
  v_perm_b32 v21, v29, v29, v9
  v_perm_b32 v22, v29, v29, v10
  v_perm_b32 v23, v29, v29, v11
  s_nop 1
  v_mfma_f32_16x16x32_bf16 v[24:27], v[20:23], a[68:71], v[24:27]
  v_mov_b32_dpp v28, v12 row_newbcast:2 row_mask:0xf bank_mask:0xf
  v_perm_b32 v16, v28, v28, v8
  v_perm_b32 v17, v28, v28, v9
  v_perm_b32 v18, v28, v28, v10
  v_perm_b32 v19, v28, v28, v11
  s_nop 1
  v_mfma_f32_16x16x32_bf16 v[24:27], v[16:19], a[72:75], v[24:27]
  v_mov_b32_dpp v29, v12 row_newbcast:3 row_mask:0xf bank_mask:0xf
  v_perm_b32 v20, v29, v29, v8
  v_perm_b32 v21, v29, v29, v9
  v_perm_b32 v22, v29, v29, v10
  v_perm_b32 v23, v29, v29, v11
  s_nop 1
  v_mfma_f32_16x16x32_bf16 v[24:27], v[20:23], a[76:79], v[24:27]
  v_mov_b32_dpp v28, v12 row_newbcast:4 row_mask:0xf bank_mask:0xf
  v_perm_b32 v16, v28, v28, v8
  v_perm_b32 v17, v28, v28, v9
  v_perm_b32 v18, v28, v28, v10
  v_perm_b32 v19, v28, v28, v11
  s_nop 1
  v_mfma_f32_16x16x32_bf16 v[24:27], v[16:19], a[80:83], v[24:27]
  v_mov_b32_dpp v29, v12 row_newbcast:5 row_mask:0xf bank_mask:0xf
  v_perm_b32 v20, v29, v29, v8
  v_perm_b32 v21, v29, v29, v9
  v_perm_b32 v22, v29, v29, v10
  v_perm_b32 v23, v29, v29, v11
  s_nop 1
  v_mfma_f32_16x16x32_bf16 v[24:27], v[20:23], a[84:87], v[24:27]
  v_mov_b32_dpp v28, v12 row_newbcast:6 row_mask:0xf bank_mask:0xf
  v_perm_b32 v16, v28, v28, v8
  v_perm_b32 v17, v28, v28, v9
  v_perm_b32 v18, v28, v28, v10
  v_perm_b32 v19, v28, v28, v11
  s_nop 1
  v_mfma_f32_16x16x32_bf16 v[24:27], v[16:19], a[88:91], v[24:27]
  v_mov_b32_dpp v29, v12 row_newbcast:7 row_mask:0xf bank_mask:0xf
  v_perm_b32 v20, v29, v29, v8
  v_perm_b32 v21, v29, v29, v9
  v_perm_b32 v22, v29, v29, v10
  v_perm_b32 v23, v29, v29, v11
  s_nop 1
  v_mfma_f32_16x16x32_bf16 v[24:27], v[20:23], a[92:95], v[24:27]
  v_mov_b32_dpp v28, v12 row_newbcast:8 row_mask:0xf bank_mask:0xf
  v_perm_b32 v16, v28, v28, v8
  v_perm_b32 v17, v28, v28, v9
  v_perm_b32 v18, v28, v28, v10
  v_perm_b32 v19, v28, v28, v11
  s_nop 1
  v_mfma_f32_16x16x32_bf16 v[24:27], v[16:19], a[96:99], v[24:27]
  v_mov_b32_dpp v29, v12 row_newbcast:9 row_mask:0xf bank_mask:0xf
  v_perm_b32 v20, v29, v29, v8
  v_perm_b32 v21, v29, v29, v9
  v_perm_b32 v22, v29, v29, v10
  v_perm_b32 v23, v29, v29, v11
  s_nop 1
  v_mfma_f32_16x16x32_bf16 v[24:27], v[20:23], a[100:103], v[24:27]
  v_mov_b32_dpp v28, v12 row_newbcast:10 row_mask:0xf bank_mask:0xf
  v_perm_b32 v16, v28, v28, v8
  v_perm_b32 v17, v28, v28, v9
  v_perm_b32 v18, v28, v28, v10
  v_perm_b32 v19, v28, v28, v11
  s_nop 1
  v_mfma_f32_16x16x32_bf16 v[24:27], v[16:19], a[104:107], v[24:27]
  v_mov_b32_dpp v29, v12 row_newbcast:11 row_mask:0xf bank_mask:0xf
  v_perm_b32 v20, v29, v29, v8
  v_perm_b32 v21, v29, v29, v9
  v_perm_b32 v22, v29, v29, v10
  v_perm_b32 v23, v29, v29, v11
  s_nop 1
  v_mfma_f32_16x16x32_bf16 v[24:27], v[20:23], a[108:111], v[24:27]
  v_mov_b32_dpp v28, v12 row_newbcast:12 row_mask:0xf bank_mask:0xf
  v_perm_b32 v16, v28, v28, v8
  v_perm_b32 v17, v28, v28, v9
  v_perm_b32 v18, v28, v28, v10
  v_perm_b32 v19, v28, v28, v11
  s_nop 1
  v_mfma_f32_16x16x32_bf16 v[24:27], v[16:19], a[112:115], v[24:27]
  v_mov_b32_dpp v29, v12 row_newbcast:13 row_mask:0xf bank_mask:0xf
  v_perm_b32 v20, v29, v29, v8
  v_perm_b32 v21, v29, v29, v9
  v_perm_b32 v22, v29, v29, v10
  v_perm_b32 v23, v29, v29, v11
  s_nop 1
  v_mfma_f32_16x16x32_bf16 v[24:27], v[20:23], a[116:119], v[24:27]
  v_mov_b32_dpp v28, v12 row_newbcast:14 row_mask:0xf bank_mask:0xf
  v_perm_b32 v16, v28, v28, v8
  v_perm_b32 v17, v28, v28, v9
  v_perm_b32 v18, v28, v28, v10
  v_perm_b32 v19, v28, v28, v11
  s_nop 1
  v_mfma_f32_16x16x32_bf16 v[24:27], v[16:19], a[120:123], v[24:27]
  v_mov_b32_dpp v29, v12 row_newbcast:15 row_mask:0xf bank_mask:0xf
  v_perm_b32 v20, v29, v29, v8
  v_perm_b32 v21, v29, v29, v9
  v_perm_b32 v22, v29, v29, v10
  v_perm_b32 v23, v29, v29, v11
  s_nop 1
  v_mfma_f32_16x16x32_bf16 v[24:27], v[20:23], a[124:127], v[24:27]
  s_nop 7
  ds_write_b128 v15, v[24:27] offset:16384
  v_lshl_add_u32 v28, v3, 4, v2
  s_lshl_b32 s3, s38, 8
  s_add_u32 s3, s3, 86016
  v_lshl_add_u32 v28, v28, 2, s3
  s_waitcnt lgkmcnt(0)
  s_barrier
  ds_read2st64_b32 v[40:41], v28 offset0:0 offset1:2
  ds_read2st64_b32 v[42:43], v28 offset0:4 offset1:6
  ds_read2st64_b32 v[44:45], v28 offset0:8 offset1:10
  ds_read2st64_b32 v[46:47], v28 offset0:12 offset1:14
  ds_read2st64_b32 v[48:49], v28 offset0:16 offset1:18
  ds_read2st64_b32 v[50:51], v28 offset0:20 offset1:22
  ds_read2st64_b32 v[52:53], v28 offset0:24 offset1:26
  ds_read2st64_b32 v[54:55], v28 offset0:28 offset1:30
  s_waitcnt lgkmcnt(0)
  v_pk_add_f32 v[40:41], v[40:41], v[48:49]
  v_pk_add_f32 v[42:43], v[42:43], v[50:51]
  v_pk_add_f32 v[44:45], v[44:45], v[52:53]
  v_pk_add_f32 v[46:47], v[46:47], v[54:55]
  v_pk_add_f32 v[40:41], v[40:41], v[44:45]
  v_pk_add_f32 v[42:43], v[42:43], v[46:47]
  v_pk_add_f32 v[40:41], v[40:41], v[42:43]
  v_cvt_pk_bf16_f32 v12, v40, v41
  s_nop 1
  v_mov_b32_dpp v28, v12 row_newbcast:0 row_mask:0xf bank_mask:0xf
  v_perm_b32 v16, v28, v28, v8
  v_perm_b32 v17, v28, v28, v9
  v_perm_b32 v18, v28, v28, v10
  v_perm_b32 v19, v28, v28, v11
  s_nop 1
  v_mfma_f32_16x16x32_bf16 v[24:27], v[16:19], a[0:3], 0
  v_mov_b32_dpp v29, v12 row_newbcast:1 row_mask:0xf bank_mask:0xf
  v_perm_b32 v20, v29, v29, v8
  v_perm_b32 v21, v29, v29, v9
  v_perm_b32 v22, v29, v29, v10
  v_perm_b32 v23, v29, v29, v11
  s_nop 1
  v_mfma_f32_16x16x32_bf16 v[24:27], v[20:23], a[4:7], v[24:27]
  v_mov_b32_dpp v28, v12 row_newbcast:2 row_mask:0xf bank_mask:0xf
  v_perm_b32 v16, v28, v28, v8
  v_perm_b32 v17, v28, v28, v9
  v_perm_b32 v18, v28, v28, v10
  v_perm_b32 v19, v28, v28, v11
  s_nop 1
  v_mfma_f32_16x16x32_bf16 v[24:27], v[16:19], a[8:11], v[24:27]
  v_mov_b32_dpp v29, v12 row_newbcast:3 row_mask:0xf bank_mask:0xf
  v_perm_b32 v20, v29, v29, v8
  v_perm_b32 v21, v29, v29, v9
  v_perm_b32 v22, v29, v29, v10
  v_perm_b32 v23, v29, v29, v11
  s_nop 1
  v_mfma_f32_16x16x32_bf16 v[24:27], v[20:23], a[12:15], v[24:27]
  v_mov_b32_dpp v28, v12 row_newbcast:4 row_mask:0xf bank_mask:0xf
  v_perm_b32 v16, v28, v28, v8
  v_perm_b32 v17, v28, v28, v9
  v_perm_b32 v18, v28, v28, v10
  v_perm_b32 v19, v28, v28, v11
  s_nop 1
  v_mfma_f32_16x16x32_bf16 v[24:27], v[16:19], a[16:19], v[24:27]
  v_mov_b32_dpp v29, v12 row_newbcast:5 row_mask:0xf bank_mask:0xf
  v_perm_b32 v20, v29, v29, v8
  v_perm_b32 v21, v29, v29, v9
  v_perm_b32 v22, v29, v29, v10
  v_perm_b32 v23, v29, v29, v11
  s_nop 1
  v_mfma_f32_16x16x32_bf16 v[24:27], v[20:23], a[20:23], v[24:27]
  v_mov_b32_dpp v28, v12 row_newbcast:6 row_mask:0xf bank_mask:0xf
  v_perm_b32 v16, v28, v28, v8
  v_perm_b32 v17, v28, v28, v9
  v_perm_b32 v18, v28, v28, v10
  v_perm_b32 v19, v28, v28, v11
  s_nop 1
  v_mfma_f32_16x16x32_bf16 v[24:27], v[16:19], a[24:27], v[24:27]
  v_mov_b32_dpp v29, v12 row_newbcast:7 row_mask:0xf bank_mask:0xf
  v_perm_b32 v20, v29, v29, v8
  v_perm_b32 v21, v29, v29, v9
  v_perm_b32 v22, v29, v29, v10
  v_perm_b32 v23, v29, v29, v11
  s_nop 1
  v_mfma_f32_16x16x32_bf16 v[24:27], v[20:23], a[28:31], v[24:27]
  v_mov_b32_dpp v28, v12 row_newbcast:8 row_mask:0xf bank_mask:0xf
  v_perm_b32 v16, v28, v28, v8
  v_perm_b32 v17, v28, v28, v9
  v_perm_b32 v18, v28, v28, v10
  v_perm_b32 v19, v28, v28, v11
  s_nop 1
  v_mfma_f32_16x16x32_bf16 v[24:27], v[16:19], a[32:35], v[24:27]
  v_mov_b32_dpp v29, v12 row_newbcast:9 row_mask:0xf bank_mask:0xf
  v_perm_b32 v20, v29, v29, v8
  v_perm_b32 v21, v29, v29, v9
  v_perm_b32 v22, v29, v29, v10
  v_perm_b32 v23, v29, v29, v11
  s_nop 1
  v_mfma_f32_16x16x32_bf16 v[24:27], v[20:23], a[36:39], v[24:27]
  v_mov_b32_dpp v28, v12 row_newbcast:10 row_mask:0xf bank_mask:0xf
  v_perm_b32 v16, v28, v28, v8
  v_perm_b32 v17, v28, v28, v9
  v_perm_b32 v18, v28, v28, v10
  v_perm_b32 v19, v28, v28, v11
  s_nop 1
  v_mfma_f32_16x16x32_bf16 v[24:27], v[16:19], a[40:43], v[24:27]
  v_mov_b32_dpp v29, v12 row_newbcast:11 row_mask:0xf bank_mask:0xf
  v_perm_b32 v20, v29, v29, v8
  v_perm_b32 v21, v29, v29, v9
  v_perm_b32 v22, v29, v29, v10
  v_perm_b32 v23, v29, v29, v11
  s_nop 1
  v_mfma_f32_16x16x32_bf16 v[24:27], v[20:23], a[44:47], v[24:27]
  v_mov_b32_dpp v28, v12 row_newbcast:12 row_mask:0xf bank_mask:0xf
  v_perm_b32 v16, v28, v28, v8
  v_perm_b32 v17, v28, v28, v9
  v_perm_b32 v18, v28, v28, v10
  v_perm_b32 v19, v28, v28, v11
  s_nop 1
  v_mfma_f32_16x16x32_bf16 v[24:27], v[16:19], a[48:51], v[24:27]
  v_mov_b32_dpp v29, v12 row_newbcast:13 row_mask:0xf bank_mask:0xf
  v_perm_b32 v20, v29, v29, v8
  v_perm_b32 v21, v29, v29, v9
  v_perm_b32 v22, v29, v29, v10
  v_perm_b32 v23, v29, v29, v11
  s_nop 1
  v_mfma_f32_16x16x32_bf16 v[24:27], v[20:23], a[52:55], v[24:27]
  v_mov_b32_dpp v28, v12 row_newbcast:14 row_mask:0xf bank_mask:0xf
  v_perm_b32 v16, v28, v28, v8
  v_perm_b32 v17, v28, v28, v9
  v_perm_b32 v18, v28, v28, v10
  v_perm_b32 v19, v28, v28, v11
  s_nop 1
  v_mfma_f32_16x16x32_bf16 v[24:27], v[16:19], a[56:59], v[24:27]
  v_mov_b32_dpp v29, v12 row_newbcast:15 row_mask:0xf bank_mask:0xf
  v_perm_b32 v20, v29, v29, v8
  v_perm_b32 v21, v29, v29, v9
  v_perm_b32 v22, v29, v29, v10
  v_perm_b32 v23, v29, v29, v11
  s_nop 1
  v_mfma_f32_16x16x32_bf16 v[24:27], v[20:23], a[60:63], v[24:27]
  v_lshrrev_b32 v30, 1, v3
  v_lshlrev_b32 v30, 11, v30
  v_lshl_add_u32 v30, v2, 5, v30
  v_and_b32 v31, 1, v3
  v_lshl_add_u32 v30, v31, 4, v30
  s_lshl_b32 s3, s39, 12
  s_lshl_b32 s40, s49, 9
  s_add_u32 s3, s3, s40
  s_add_u32 s3, s3, 6291456
  v_add_u32 v30, s3, v30
  global_store_dwordx4 v30, v[24:27], s[56:57] sc1
  s_cmp_lg_u32 s38, 0
  s_nop 0
  s_cbranch_scc1 L_F_end
  s_lshr_b32 s38, s37, 4
  s_and_b32 s39, s37, 15
  v_lshlrev_b32 v47, 2, v0
  s_lshl_b32 s40, s38, 10
  v_add_u32 v10, s40, v47
  global_load_dword v44, v10, s[4:5]
  global_load_dword v45, v47, s[18:19]
  v_lshrrev_b32 v47, 3, v0
  v_and_b32 v48, 7, v0
  v_lshlrev_b32 v48, 4, v48
  v_lshl_add_u32 v5, v47, 14, v48
  v_lshl_add_u32 v48, v47, 13, v48
  s_lshl_b32 s3, s39, 7
  s_lshl_b32 s40, s38, 19
  s_add_u32 s40, s40, s3
  s_add_u32 s40, s40, 4198400
  v_add_u32 v5, s40, v5
  v_add_u32 v6, 0x2000, v5
  s_lshl_b32 s40, s38, 11
  s_add_u32 s40, s40, s3
  s_add_u32 s40, s40, 6291456
  v_add_u32 v7, s40, v48
  v_add_u32 v8, 0x1000, v7
  s_lshl_b32 s40, s38, 10
  s_add_u32 s40, s40, 131072
  v_lshl_add_u32 v9, v47, 5, s40
  global_load_dwordx4 v[12:15], v9, s[56:57] sc1
  global_load_dwordx4 v[16:19], v9, s[56:57] offset:16 sc1
  global_load_dwordx4 v[64:67], v5, s[56:57] offset:-4096 sc1
  global_load_dwordx4 v[68:71], v5, s[56:57] offset:-2048 sc1
  global_load_dwordx4 v[72:75], v5, s[56:57] offset:0 sc1
  global_load_dwordx4 v[76:79], v5, s[56:57] offset:2048 sc1
  global_load_dwordx4 v[80:83], v6, s[56:57] offset:-4096 sc1
  global_load_dwordx4 v[84:87], v6, s[56:57] offset:-2048 sc1
  global_load_dwordx4 v[88:91], v6, s[56:57] offset:0 sc1
  global_load_dwordx4 v[92:95], v6, s[56:57] offset:2048 sc1
  global_load_dwordx4 v[36:39], v7, s[56:57] sc1
  global_load_dwordx4 v[40:43], v8, s[56:57] sc1
  s_waitcnt vmcnt(12)
  v_lshlrev_b32 v47, 16, v44
  v_lshlrev_b32 v48, 16, v45
  v_and_b32 v44, 0xffff0000, v44
  v_and_b32 v45, 0xffff0000, v45
  v_mul_f32 v47, v47, v48
  v_mul_f32 v48, v44, v45
  v_cvt_pk_bf16_f32 v47, v47, v48
  v_lshlrev_b32 v48, 16, v47
  v_and_b32 v47, 0xffff0000, v47
  v_add_f32 v46, v47, v48
  s_nop 1
  v_add_f32_dpp v46, v46, v46 row_ror:8 row_mask:0xf bank_mask:0xf
  s_nop 1
  v_add_f32_dpp v46, v46, v46 row_ror:4 row_mask:0xf bank_mask:0xf
  s_nop 1
  v_add_f32_dpp v46, v46, v46 row_ror:2 row_mask:0xf bank_mask:0xf
  s_nop 1
  v_add_f32_dpp v46, v46, v46 row_ror:1 row_mask:0xf bank_mask:0xf
  v_mov_b32 v47, v46
  s_nop 1
  v_permlane16_swap_b32 v46, v47
  v_add_f32 v46, v46, v47
  v_mov_b32 v47, v46
  s_nop 1
  v_permlane32_swap_b32 v46, v47
  v_add_f32 v46, v46, v47
  s_lshl_b32 s3, s36, 2
  v_mov_b32 v47, s3
  ds_write_b32 v47, v46 offset:2048
  s_waitcnt lgkmcnt(0)
  s_barrier
  ds_read_b128 v[50:53], v4 offset:2048
  s_waitcnt lgkmcnt(0)
  v_pk_add_f32 v[50:51], v[50:51], v[52:53]
  v_add_f32 v46, v50, v51
  v_cvt_pk_bf16_f32 v46, v46, v46
  v_lshlrev_b32 v46, 16, v46
  v_mul_f32 v46, 0xbfb8aa3b, v46
  v_exp_f32 v46, v46
  s_nop 0
  v_add_f32 v46, 1.0, v46
  v_rcp_f32 v46, v46
  s_nop 0
  v_cvt_pk_bf16_f32 v46, v46, v46
  v_lshlrev_b32 v46, 16, v46
  v_sub_f32 v50, 1.0, v46
  v_cvt_pk_bf16_f32 v50, v50, v50
  v_lshlrev_b32 v50, 16, v50
  v_and_b32 v47, 7, v0
  v_lshrrev_b32 v48, 4, v0
  v_lshl_add_u32 v47, v47, 2, v48
  s_lshl_b32 s3, s37, 6
  v_lshl_add_u32 v10, v47, 1, s3
  s_mov_b32 s40, 0
  s_nop 0
L_F_chk:
  s_waitcnt vmcnt(0)
  v_max_u32 v47, v12, v13
  v_max_u32 v48, v14, v15
  v_max3_u32 v47, v16, v17, v47
  v_max3_u32 v48, v18, v19, v48
  v_max3_u32 v47, v36, v37, v47
  v_max3_u32 v48, v38, v39, v48
  v_max3_u32 v47, v40, v41, v47
  v_max3_u32 v48, v42, v43, v48
  v_max3_u32 v47, v64, v65, v47
  v_max3_u32 v48, v66, v67, v48
  v_max3_u32 v47, v68, v69, v47
  v_max3_u32 v48, v70, v71, v48
  v_max3_u32 v47, v72, v73, v47
  v_max3_u32 v48, v74, v75, v48
  v_max3_u32 v47, v76, v77, v47
  v_max3_u32 v48, v78, v79, v48
  v_max3_u32 v47, v80, v81, v47
  v_max3_u32 v48, v82, v83, v48
  v_max3_u32 v47, v84, v85, v47
  v_max3_u32 v48, v86, v87, v48
  v_max3_u32 v47, v88, v89, v47
  v_max3_u32 v48, v90, v91, v48
  v_max3_u32 v47, v92, v93, v47
  v_max3_u32 v48, v94, v95, v48
  v_max_u32 v47, v47, v48
  v_cmp_eq_u32 vcc, -1, v47
  s_nop 4
  s_cbranch_vccz L_F_go
  s_add_u32 s40, s40, 1
  s_cmp_ge_u32 s40, 0x8000
  s_cbranch_scc1 L_F_go
  s_mov_b64 exec, vcc
  s_sleep 2
  global_load_dwordx4 v[12:15], v9, s[56:57] sc1
  global_load_dwordx4 v[16:19], v9, s[56:57] offset:16 sc1
  global_load_dwordx4 v[64:67], v5, s[56:57] offset:-4096 sc1
  global_load_dwordx4 v[68:71], v5, s[56:57] offset:-2048 sc1
  global_load_dwordx4 v[72:75], v5, s[56:57] offset:0 sc1
  global_load_dwordx4 v[76:79], v5, s[56:57] offset:2048 sc1
  global_load_dwordx4 v[80:83], v6, s[56:57] offset:-4096 sc1
  global_load_dwordx4 v[84:87], v6, s[56:57] offset:-2048 sc1
  global_load_dwordx4 v[88:91], v6, s[56:57] offset:0 sc1
  global_load_dwordx4 v[92:95], v6, s[56:57] offset:2048 sc1
  global_load_dwordx4 v[36:39], v7, s[56:57] sc1
  global_load_dwordx4 v[40:43], v8, s[56:57] sc1
  s_branch L_F_chk
L_F_go:
  s_mov_b64 exec, -1
  v_max3_f32 v47, v12, v14, v16
  v_max_f32 v47, v47, v18
  v_sub_f32 v12, v12, v47
  v_sub_f32 v14, v14, v47
  v_sub_f32 v16, v16, v47
  v_sub_f32 v18, v18, v47
  v_exp_f32 v12, v12
  v_exp_f32 v14, v14
  v_exp_f32 v16, v16
  v_exp_f32 v18, v18
  v_mul_f32 v47, v12, v13
  v_fmac_f32 v47, v14, v15
  v_fmac_f32 v47, v16, v17
  v_fmac_f32 v47, v18, v19
  v_rcp_f32 v47, v47
  s_nop 0
  v_mul_f32 v12, v12, v47
  v_mul_f32 v14, v14, v47
  v_mul_f32 v16, v16, v47
  v_mul_f32 v18, v18, v47
  v_pk_add_f32 v[64:65], v[64:65], v[68:69]
  v_pk_add_f32 v[66:67], v[66:67], v[70:71]
  v_mul_f32 v64, v64, v12
  v_mul_f32 v65, v65, v12
  v_mul_f32 v66, v66, v12
  v_mul_f32 v67, v67, v12
  v_pk_add_f32 v[72:73], v[72:73], v[76:77]
  v_pk_add_f32 v[74:75], v[74:75], v[78:79]
  v_fmac_f32 v64, v72, v14
  v_fmac_f32 v65, v73, v14
  v_fmac_f32 v66, v74, v14
  v_fmac_f32 v67, v75, v14
  v_pk_add_f32 v[80:81], v[80:81], v[84:85]
  v_pk_add_f32 v[82:83], v[82:83], v[86:87]
  v_fmac_f32 v64, v80, v16
  v_fmac_f32 v65, v81, v16
  v_fmac_f32 v66, v82, v16
  v_fmac_f32 v67, v83, v16
  v_pk_add_f32 v[88:89], v[88:89], v[92:93]
  v_pk_add_f32 v[90:91], v[90:91], v[94:95]
  v_fmac_f32 v64, v88, v18
  v_fmac_f32 v65, v89, v18
  v_fmac_f32 v66, v90, v18
  v_fmac_f32 v67, v91, v18
  v_add_f32 v68, v36, v40
  v_add_f32 v69, v37, v41
  v_add_f32 v70, v38, v42
  v_add_f32 v71, v39, v43
  v_add_f32_dpp v64, v64, v64 row_ror:8 row_mask:0xf bank_mask:0xf
  v_add_f32_dpp v65, v65, v65 row_ror:8 row_mask:0xf bank_mask:0xf
  v_add_f32_dpp v66, v66, v66 row_ror:8 row_mask:0xf bank_mask:0xf
  v_add_f32_dpp v67, v67, v67 row_ror:8 row_mask:0xf bank_mask:0xf
  v_add_f32_dpp v68, v68, v68 row_ror:8 row_mask:0xf bank_mask:0xf
  v_add_f32_dpp v69, v69, v69 row_ror:8 row_mask:0xf bank_mask:0xf
  v_add_f32_dpp v70, v70, v70 row_ror:8 row_mask:0xf bank_mask:0xf
  v_add_f32_dpp v71, v71, v71 row_ror:8 row_mask:0xf bank_mask:0xf
  v_permlane16_swap_b32 v64, v65
  v_permlane16_swap_b32 v66, v67
  v_permlane16_swap_b32 v68, v69
  v_permlane16_swap_b32 v70, v71
  v_add_f32 v64, v64, v65
  v_add_f32 v66, v66, v67
  v_add_f32 v68, v68, v69
  v_add_f32 v70, v70, v71
  v_permlane32_swap_b32 v64, v66
  s_nop 0
  v_permlane32_swap_b32 v68, v70
  v_add_f32 v64, v64, v66
  v_add_f32 v65, v68, v70
  v_lshlrev_b32 v47, 3, v0
  ds_write_b64 v47, v[64:65]
  s_waitcnt lgkmcnt(0)
  s_barrier
  s_cmp_lg_u32 s36, 0
  s_cbranch_scc1 L_F_end
  ds_read_b64 v[64:65], v47 offset:0
  ds_read_b64 v[66:67], v47 offset:512
  ds_read_b64 v[68:69], v47 offset:1024
  ds_read_b64 v[70:71], v47 offset:1536
  s_waitcnt lgkmcnt(0)
  v_pk_add_f32 v[64:65], v[64:65], v[66:67]
  v_pk_add_f32 v[68:69], v[68:69], v[70:71]
  v_pk_add_f32 v[64:65], v[64:65], v[68:69]
  v_cvt_pk_bf16_f32 v47, v64, v65
  v_lshlrev_b32 v64, 16, v47
  v_and_b32 v65, 0xffff0000, v47
  v_mul_f32 v64, v64, v46
  v_mul_f32 v65, v65, v50
  v_cvt_pk_bf16_f32 v47, v64, v65
  v_lshlrev_b32 v64, 16, v47
  v_and_b32 v65, 0xffff0000, v47
  v_add_f32 v64, v64, v65
  v_cvt_pk_bf16_f32 v64, v64, v64
  s_mov_b32 exec_lo, 0x00ff00ff
  s_mov_b32 exec_hi, 0x00ff00ff
  global_store_short v10, v64, s[52:53]
L_F_end:
  s_endpgm
.section .rodata,"a"
.p2align 6
.amdhsa_kernel gated_mix__mha_block_cached__compressed_kv_cla__decode_kernel
  .amdhsa_next_free_vgpr 256
  .amdhsa_next_free_sgpr 102
  .amdhsa_accum_offset 128
  .amdhsa_group_segment_fixed_size 0
  .amdhsa_kernarg_size 120
  .amdhsa_user_sgpr_count 2
  .amdhsa_user_sgpr_kernarg_segment_ptr 1
  .amdhsa_system_sgpr_workgroup_id_x 1
.end_amdhsa_kernel
```
